```python
import torch

def _softmax(x, axis=-1):
    return torch.softmax(x, dim=axis)
def _gelu(x):
    return torch.nn.functional.gelu(x, approximate="tanh")
def _silu(x):
    return torch.nn.functional.silu(x)
def _sigmoid(x):
    return torch.sigmoid(x)
def _layernorm(x, axis=-1, eps=1e-5):
    m = x.mean(dim=axis, keepdim=True)
    v = x.var(dim=axis, keepdim=True, unbiased=False)
    return (x - m) / torch.sqrt(v + eps)
def _scatter_add(tgt, idx, src, axis=0):
    return tgt.clone().index_add_(axis, idx, src)
def _segment_sum(src, seg, n):
    out = torch.zeros((n,) + src.shape[1:], dtype=src.dtype)
    return out.index_add_(0, seg, src)
def _pad(x, pw):
    flat = tuple(v for pair in reversed(pw) for v in pair)
    return torch.nn.functional.pad(x, flat)

kernel_name = 'gather_scatter__mpnn_edge_mlp__graph'

def setup_inputs():

    _w = (lambda a: (lambda t: t.to(torch.bfloat16) if t.is_floating_point() else t)(torch.as_tensor(a)))
    N, deg, D, De = 25000, 32, 64, max(0, 1)
    E = N * deg
    return {
        "x": _w((lambda *s: torch.randn(*s, dtype=torch.bfloat16) * 0.05)(N, D)),
        "e_attr": _w((lambda *s: torch.randn(*s, dtype=torch.bfloat16) * 0.4)(E, De)),
        "src": _w((lambda lo, hi, *s: torch.randint(lo, hi, s))(0, N, E).to(torch.int64)),
        "dst": _w((lambda lo, hi, *s: torch.randint(lo, hi, s))(0, N, E).to(torch.int64)),
        "w_msg": _w((lambda *s: torch.randn(*s, dtype=torch.bfloat16) * 0.4)(2 * D + De, D)),
        "w_upd": _w((lambda *s: torch.randn(*s, dtype=torch.bfloat16) * 0.05)(2 * D, D)),
    }

def reference(x, e_attr, src, dst, w_msg, w_upd):
    N, D = x.shape
    m_in = torch.concatenate([x[src], x[dst], e_attr], axis=-1)
    msg = _silu(m_in @ w_msg)
    agg = _segment_sum(msg, dst, N)
    return _silu(torch.concatenate([x, agg], axis=-1) @ w_upd)
```

```asm
; @launch grid=(256,1,1) block=(1024,1,1) lds=161408
.amdgcn_target "amdgcn-amd-amdhsa--gfx950"
.text
.globl gather_scatter__mpnn_edge_mlp__graph_kernel
.p2align 8
.type gather_scatter__mpnn_edge_mlp__graph_kernel,@function
gather_scatter__mpnn_edge_mlp__graph_kernel:
    s_cmp_ge_u32 s2, 256
    s_cbranch_scc1 K2_EXIT
    s_load_dwordx16 s[4:19], s[0:1], 0
    s_load_dwordx2 s[20:21], s[0:1], 64
    v_lshrrev_b32 v1, 6, v0
    s_and_b32 s3, s2, 7
    v_readfirstlane_b32 s22, v1
    s_lshl_b32 s3, s3, 5
    s_lshr_b32 s89, s2, 3
    s_or_b32 s89, s89, s3
    s_mov_b64 s[82:83], 0
    s_mov_b32 s3, -1
    s_sub_u32 s23, s22, 13
    s_mov_b32 s46, 67328
    s_mov_b32 s47, 8
    s_cmp_ge_u32 s22, 13
    s_cbranch_scc1 P_ROLE
    s_cmp_lt_u32 s2, 250
    s_cbranch_scc1 SORT_ROLE
    s_mul_i32 s3, s2, 3
    s_add_u32 s3, s3, s22
    s_sub_u32 s3, s3, 750
    s_mov_b32 s23, s22
    s_mov_b32 s46, 38656
    s_mov_b32 s47, 12
    s_cmp_lt_u32 s22, 3
    s_cbranch_scc1 P_ROLE
    s_waitcnt lgkmcnt(0)
    s_mov_b64 s[24:25], s[4:5]
    s_mov_b32 s26, 3200000
    s_mov_b32 s27, 0x20000
    s_mov_b64 s[36:37], s[12:13]
    s_mov_b32 s38, 16512
    s_mov_b32 s39, 0x20000
    s_barrier
    v_mov_b32 v61, 0
    v_mov_b32 v62, 0
    v_mov_b64 v[20:21], 0
    s_cmp_lg_u32 s22, 11
    s_cbranch_scc1 NONCE1I
    s_mov_b32 s52, 65536
    v_mov_b32 v12, 0
NONCEI:
    s_waitcnt vmcnt(0)
    v_readfirstlane_b32 s53, v62
    s_sub_u32 s52, s52, 1
    s_cmp_eq_u32 s52, 0
    s_cbranch_scc1 NONCE2I
    s_cmp_lg_u32 s53, 0
    s_cbranch_scc1 NONCE2I
    s_sleep 8
    global_load_dwordx2 v[62:63], v12, s[18:19] offset:248 sc1
    s_branch NONCEI
NONCE2I:
    ds_write_b64 v12, v[62:63] offset:1160
NONCE1I:
    s_mov_b64 s[40:41], s[14:15]
    s_mov_b32 s42, 16384
    s_mov_b32 s43, 0x20000
    v_lshlrev_b32 v124, 4, v0
    s_lshl_b32 s52, s22, 10
    s_add_u32 s53, s52, 1792
    s_mov_b32 m0, s53
    v_add_u32 v125, 0x2000, v124
    buffer_load_dwordx4 v124, s[40:43], 0 offen lds
    s_add_u32 s53, s52, 18176
    s_mov_b32 m0, s53
    v_lshlrev_b32 v126, 1, v0
    v_and_b32 v126, 0x70, v126
    buffer_load_dwordx4 v125, s[36:39], 0 offen lds
    v_xor_b32 v126, v126, v124
    s_mul_i32 s90, s89, 12544
    v_add_u32 v126, s90, v126
    s_and_b32 s53, s22, 14
    s_cmp_lg_u32 s53, 12
    s_cbranch_scc1 BD_0
    s_add_u32 s53, s52, 130688
    s_mov_b32 m0, s53
    s_nop 0
    buffer_load_dwordx4 v126, s[24:27], 0 offen lds
BD_0:
    s_branch PH1_DONE
SORT_ROLE:
    s_movk_i32 s3, 800
    v_cmp_gt_u32 s[44:45], s3, v0
    v_lshlrev_b32 v1, 4, v0
    v_lshlrev_b32 v2, 3, v0
    v_and_b32 v7, 63, v0
    v_lshlrev_b32 v6, 4, v7
    v_lshlrev_b32 v7, 1, v7
    v_add_u32 v7, 0x4000, v7
    s_mul_i32 s3, s2, 12800
    s_mul_i32 s23, s2, 6400
    s_waitcnt lgkmcnt(0)
    s_add_u32 s56, s10, s3
    s_addc_u32 s57, s11, 0
    s_mov_b32 s58, 12800
    s_mov_b32 s59, 0x20000
    s_add_u32 s60, s8, s3
    s_addc_u32 s61, s9, 0
    s_mov_b32 s62, 12800
    s_mov_b32 s63, 0x20000
    s_add_u32 s64, s6, s23
    s_addc_u32 s65, s7, 0
    s_mov_b32 s66, 6400
    s_mov_b32 s67, 0x20000
    s_mov_b64 s[36:37], s[12:13]
    s_mov_b32 s38, 16512
    s_mov_b32 s39, 0x20000
    buffer_load_dwordx4 v[16:19], v1, s[56:59], 0 offen
    buffer_load_dwordx4 v[8:11], v1, s[60:63], 0 offen
    buffer_load_dwordx2 v[24:25], v2, s[64:67], 0 offen
    buffer_load_ushort v7, v7, s[36:39], 0 offen
    s_cmp_lg_u32 s22, 0
    s_cbranch_scc1 S1
    v_mov_b64 v[28:29], 0
    v_mov_b64 v[30:31], 0
    ds_write_b128 v6, v[28:31] offset:38656
    s_waitcnt lgkmcnt(0)
S1:
    s_barrier
    s_add_u32 s68, s20, 3276800
    s_addc_u32 s69, s21, 0
    s_add_u32 s68, s68, s3
    s_addc_u32 s69, s69, 0
    s_mov_b32 s70, 12800
    s_mov_b32 s71, 0x20000
    s_mul_i32 s3, s2, 3200
    s_add_u32 s72, s20, 6553600
    s_addc_u32 s73, s21, 0
    s_add_u32 s72, s72, s3
    s_addc_u32 s73, s73, 0
    s_mov_b32 s74, 3200
    s_mov_b32 s75, 0x20000
    s_mov_b64 s[24:25], s[4:5]
    s_mov_b32 s26, 3200000
    s_mov_b32 s27, 0x20000
    s_mov_b64 s[32:33], s[20:21]
    s_mov_b32 s34, 9961472
    s_mov_b32 s35, 0x20000
    s_mov_b64 exec, s[44:45]
    v_mov_b32 v5, 1
    s_movk_i32 s46, 98
    s_waitcnt vmcnt(3)
    v_mul_u32_u24 v32, 0xa730, v16
    v_lshrrev_b32 v40, 22, v32
    v_lshlrev_b32 v32, 2, v40
    v_mul_u32_u24 v28, s46, v40
    ds_add_rtn_u32 v40, v32, v5 offset:38656
    v_sub_u32 v16, v16, v28
    v_mul_u32_u24 v33, 0xa730, v17
    v_lshrrev_b32 v41, 22, v33
    v_lshlrev_b32 v33, 2, v41
    v_mul_u32_u24 v28, s46, v41
    ds_add_rtn_u32 v41, v33, v5 offset:38656
    v_sub_u32 v17, v17, v28
    v_mul_u32_u24 v34, 0xa730, v18
    v_lshrrev_b32 v42, 22, v34
    v_lshlrev_b32 v34, 2, v42
    v_mul_u32_u24 v28, s46, v42
    ds_add_rtn_u32 v42, v34, v5 offset:38656
    v_sub_u32 v18, v18, v28
    v_mul_u32_u24 v35, 0xa730, v19
    v_lshrrev_b32 v43, 22, v35
    v_lshlrev_b32 v35, 2, v43
    v_mul_u32_u24 v28, s46, v43
    ds_add_rtn_u32 v43, v35, v5 offset:38656
    v_sub_u32 v19, v19, v28
    s_mov_b64 exec, -1
    v_mov_b32 v5, 1
    v_mov_b32 v61, 0
    s_mov_b32 s46, 40704
    s_waitcnt lgkmcnt(0)
    s_mov_b64 exec, 1
    ds_add_u32 v61, v5 offset:1168
LS_A:
    ds_read_b32 v60, v61 offset:1168
    s_waitcnt lgkmcnt(0)
    v_readfirstlane_b32 s53, v60
    s_cmp_ge_u32 s53, 13
    s_cbranch_scc1 LSX_A
    s_sleep 1
    s_branch LS_A
LSX_A:
    s_mov_b64 exec, -1
    ds_read_b128 v[64:67], v6 offset:38656
    s_cmp_lg_u32 s22, 11
    s_cbranch_scc1 NI1
    global_load_dwordx2 v[62:63], v61, s[18:19] offset:248 sc1
NI1:
    s_waitcnt lgkmcnt(0)
    v_add_u32 v12, v64, v65
    v_add_u32 v13, v12, v66
    v_add_u32 v14, v13, v67
    v_mov_b32 v68, v14
    s_nop 1
    v_add_u32_dpp v68, v68, v68 row_shr:1 row_mask:0xf bank_mask:0xf bound_ctrl:0
    s_nop 1
    v_add_u32_dpp v68, v68, v68 row_shr:2 row_mask:0xf bank_mask:0xf bound_ctrl:0
    s_nop 1
    v_add_u32_dpp v68, v68, v68 row_shr:4 row_mask:0xf bank_mask:0xf bound_ctrl:0
    s_nop 1
    v_add_u32_dpp v68, v68, v68 row_shr:8 row_mask:0xf bank_mask:0xf bound_ctrl:0
    s_nop 1
    v_add_u32_dpp v68, v68, v68 row_bcast:15 row_mask:0xa bank_mask:0xf
    s_nop 1
    v_add_u32_dpp v68, v68, v68 row_bcast:31 row_mask:0xc bank_mask:0xf
    v_sub_u32 v68, v68, v14
    v_add_u32 v69, v68, v64
    v_add_u32 v70, v68, v12
    v_add_u32 v71, v68, v13
    v_lshl_add_u32 v20, v68, 2, s46
    v_lshl_add_u32 v21, v69, 2, s46
    v_lshl_add_u32 v22, v70, 2, s46
    v_lshl_add_u32 v23, v71, 2, s46
    ds_write_b128 v6, v[20:23] offset:39680
    s_mov_b64 exec, s[44:45]
    s_waitcnt lgkmcnt(0)
    ds_read_b32 v32, v32 offset:39680
    ds_read_b32 v33, v33 offset:39680
    ds_read_b32 v34, v34 offset:39680
    ds_read_b32 v35, v35 offset:39680
    s_cmp_eq_u32 s22, 11
    s_cbranch_scc1 NI2
    s_waitcnt vmcnt(0)
NI2:
    s_waitcnt vmcnt(1)
    s_mov_b32 s3, 0xffff0000
    v_lshl_or_b32 v48, v24, 16, v8
    v_and_or_b32 v49, v24, s3, v9
    v_lshl_or_b32 v50, v25, 16, v10
    v_and_or_b32 v51, v25, s3, v11
    s_waitcnt lgkmcnt(0)
    v_lshl_add_u32 v32, v40, 2, v32
    ds_write_b32 v32, v48
    v_lshrrev_b32 v36, 2, v32
    ds_write_b8 v36, v16 offset:43328
    v_lshl_add_u32 v33, v41, 2, v33
    ds_write_b32 v33, v49
    v_lshrrev_b32 v37, 2, v33
    ds_write_b8 v37, v17 offset:43328
    v_lshl_add_u32 v34, v42, 2, v34
    ds_write_b32 v34, v50
    v_lshrrev_b32 v38, 2, v34
    ds_write_b8 v38, v18 offset:43328
    v_lshl_add_u32 v35, v43, 2, v35
    ds_write_b32 v35, v51
    v_lshrrev_b32 v39, 2, v35
    ds_write_b8 v39, v19 offset:43328
    v_max3_f32 v28, |v48|, |v49|, |v50|
    v_max_f32 v28, |v51|, v28
    s_mov_b64 exec, -1
    s_mov_b64 s[40:41], s[14:15]
    s_mov_b32 s42, 16384
    s_mov_b32 s43, 0x20000
    v_lshlrev_b32 v124, 4, v0
    s_lshl_b32 s52, s22, 10
    s_add_u32 s53, s52, 1792
    s_mov_b32 m0, s53
    v_add_u32 v125, 0x2000, v124
    buffer_load_dwordx4 v124, s[40:43], 0 offen lds
    s_add_u32 s53, s52, 18176
    s_mov_b32 m0, s53
    v_lshlrev_b32 v126, 1, v0
    v_and_b32 v126, 0x70, v126
    buffer_load_dwordx4 v125, s[36:39], 0 offen lds
    v_xor_b32 v126, v126, v124
    s_mul_i32 s90, s89, 12544
    v_add_u32 v126, s90, v126
    s_and_b32 s53, s22, 14
    s_cmp_lg_u32 s53, 12
    s_cbranch_scc1 BD_1
    s_add_u32 s53, s52, 130688
    s_mov_b32 m0, s53
    s_nop 0
    buffer_load_dwordx4 v126, s[24:27], 0 offen lds
BD_1:
    s_waitcnt lgkmcnt(0)
    s_mov_b64 exec, 1
    ds_add_u32 v61, v5 offset:1172
LS_B:
    ds_read_b32 v60, v61 offset:1172
    s_waitcnt lgkmcnt(0)
    v_readfirstlane_b32 s53, v60
    s_cmp_ge_u32 s53, 13
    s_cbranch_scc1 LSX_B
    s_sleep 1
    s_branch LS_B
LSX_B:
    s_mov_b64 exec, -1
    v_mov_b32 v60, v28
    ds_read_b128 v[24:27], v1 offset:40704
    s_cmp_gt_u32 s22, 3
    s_cbranch_scc1 CO1
    ds_read_b128 v[28:31], v1 offset:53504
    s_waitcnt lgkmcnt(0)
    buffer_store_dwordx4 v[28:31], v1, s[72:75], 0 offen sc1
CO1:
    s_waitcnt lgkmcnt(0)
    buffer_store_dwordx4 v[24:27], v1, s[68:71], 0 offen sc1
    v_and_b32 v7, 0x7fff, v7
    s_nop 1
    v_max_u32_dpp v7, v7, v7 row_shr:1 row_mask:0xf bank_mask:0xf bound_ctrl:0
    s_nop 1
    v_max_u32_dpp v7, v7, v7 row_shr:2 row_mask:0xf bank_mask:0xf bound_ctrl:0
    s_nop 1
    v_max_u32_dpp v7, v7, v7 row_shr:4 row_mask:0xf bank_mask:0xf bound_ctrl:0
    s_nop 1
    v_max_u32_dpp v7, v7, v7 row_shr:8 row_mask:0xf bank_mask:0xf bound_ctrl:0
    s_nop 1
    v_max_u32_dpp v7, v7, v7 row_bcast:15 row_mask:0xa bank_mask:0xf
    s_nop 1
    v_max_u32_dpp v7, v7, v7 row_bcast:31 row_mask:0xc bank_mask:0xf
    s_nop 1
    v_readlane_b32 s47, v7, 63
    s_lshl_b32 s47, s47, 16
    s_mov_b64 exec, s[44:45]
    v_mul_f32 v60, s47, v60
    v_cmp_ngt_f32 vcc, 0x40dd7fb6, v60
    s_mov_b64 s[82:83], vcc
    s_mov_b64 exec, -1
    s_cmp_lg_u32 s22, 11
    s_cbranch_scc1 NONCE1S
    s_mov_b32 s52, 65536
    s_waitcnt vmcnt(3)
NONCES:
    v_readfirstlane_b32 s53, v62
    s_sub_u32 s52, s52, 1
    s_cmp_eq_u32 s52, 0
    s_cbranch_scc1 NONCE2S
    s_cmp_lg_u32 s53, 0
    s_cbranch_scc1 NONCE2S
    global_load_dwordx2 v[62:63], v61, s[18:19] offset:248 sc1
    s_waitcnt vmcnt(0)
    s_branch NONCES
NONCE2S:
    ds_write_b64 v61, v[62:63] offset:1160
NONCE1S:
    s_cmp_lg_u32 s22, 12
    s_cbranch_scc1 S2
    v_add_u32 v19, v71, v67
    v_lshl_or_b32 v20, v69, 12, v68
    v_lshl_or_b32 v20, v70, 24, v20
    v_lshrrev_b32 v21, 8, v70
    v_lshl_or_b32 v21, v71, 4, v21
    v_lshl_or_b32 v21, v19, 16, v21
S2:
    s_branch PH1_DONE
P_ROLE:
    v_and_b32 v2, 63, v0
    v_lshlrev_b32 v1, 4, v2
    v_lshlrev_b32 v3, 1, v2
    v_and_b32 v3, 0x70, v3
    v_xor_b32 v3, v3, v1
    v_mov_b32 v61, s47
    s_lshl_b32 s47, s23, 10
    v_add_u32 v5, s47, v1
    v_add_u32 v6, 0x1800, v5
    s_add_u32 s52, s46, s47
    s_mov_b32 m0, s52
    s_lshl_b32 s62, s23, 12
    s_add_u32 s47, s62, s46
    s_add_u32 s47, s47, 9216
    s_mov_b32 s23, s46
    s_cmp_lg_u32 s3, -1
    s_cbranch_scc1 PX
    s_mul_i32 s46, s89, 12544
    s_add_u32 s46, s46, s62
    s_add_u32 s62, s62, 130688
    v_add_u32 v88, s46, v3
    v_add_u32 v92, s46, v1
    v_add_u32 v89, s46, v3
    v_add_u32 v93, s46, v1
    v_add_u32 v90, s46, v3
    v_add_u32 v94, s46, v1
    v_add_u32 v91, s46, v3
    v_add_u32 v95, s46, v1
    s_branch PY
PX:
    s_mov_b32 s62, s47
    s_mul_i32 s46, s3, 200704
    s_add_u32 s46, s46, 12288
    v_bfe_u32 v4, v0, 4, 2
    s_movk_i32 s53, 12544
    v_mul_u32_u24 v4, s53, v4
    v_add_u32 v4, s46, v4
    v_and_b32 v7, 0xf0, v3
    v_add_u32 v88, v4, v7
    v_and_b32 v7, 0xf0, v1
    v_add_u32 v92, v4, v7
    v_add_u32 v89, 49152, v88
    v_add_u32 v93, 49152, v92
    v_add_u32 v90, 98304, v88
    v_add_u32 v94, 98304, v92
    v_add_u32 v91, 147456, v88
    v_add_u32 v95, 147456, v92
PY:
    s_waitcnt lgkmcnt(0)
    s_mov_b64 s[36:37], s[12:13]
    s_mov_b32 s38, 16512
    s_mov_b32 s39, 0x20000
    buffer_load_dwordx4 v5, s[36:39], 0 offen lds
    buffer_load_dwordx4 v5, s[36:39], 0 offen offset:3072 lds
    s_add_u32 s52, s52, 0x1800
    s_mov_b32 m0, s52
    s_mov_b64 s[24:25], s[4:5]
    s_mov_b32 s26, 3200000
    s_mov_b32 s27, 0x20000
    buffer_load_dwordx4 v6, s[36:39], 0 offen lds
    s_mov_b32 m0, s62
    s_nop 0
    buffer_load_dwordx4 v88, s[24:27], 0 offen offset:0 lds
    buffer_load_dwordx4 v89, s[24:27], 0 offen offset:1024 lds
    buffer_load_dwordx4 v90, s[24:27], 0 offen offset:2048 lds
    buffer_load_dwordx4 v91, s[24:27], 0 offen offset:3072 lds
    s_cmp_lg_u32 s22, 15
    s_cbranch_scc1 P1
    v_mov_b64 v[28:29], 0
    v_mov_b64 v[30:31], 0
    ds_write_b64 v28, v[28:29] offset:1152
    ds_write_b128 v28, v[28:31] offset:1168
    s_cmp_lg_u32 s2, 0
    s_cbranch_scc1 P0
    s_memrealtime s[52:53]
    s_waitcnt lgkmcnt(0)
    s_or_b32 s52, s52, 1
    v_mov_b32 v30, s52
    v_mov_b32 v31, s53
    s_mov_b64 exec, 1
    global_store_dwordx2 v28, v[30:31], s[18:19] offset:248 sc1
    s_mov_b64 exec, -1
P0:
    s_waitcnt lgkmcnt(0)
P1:
    s_barrier
    s_mov_b64 s[28:29], s[20:21]
    s_mov_b32 s30, 3200000
    s_mov_b32 s31, 0x20000
    v_and_b32 v7, 31, v0
    v_bfe_u32 v6, v0, 5, 1
    v_add_u32 v5, s47, v3
    v_lshlrev_b32 v4, 4, v0
    v_and_b32 v4, 0x70, v4
    v_lshl_add_u32 v4, v7, 7, v4
    v_add_u32 v45, s62, v4
    v_add_u32 v4, s47, v4
    v_lshlrev_b32 v44, 4, v6
    v_xor_b32 v44, v44, v45
    v_xor_b32 v45, 32, v44
    v_xor_b32 v46, 64, v44
    v_xor_b32 v47, 96, v44
    v_lshlrev_b32 v40, 6, v6
    v_xor_b32 v40, v40, v4
    v_xor_b32 v41, 16, v40
    v_xor_b32 v42, 32, v40
    v_xor_b32 v43, 48, v40
    v_bfe_u32 v48, v7, 2, 1
    v_lshlrev_b32 v48, 4, v48
    v_and_b32 v49, 3, v7
    v_add_u32 v48, v48, v49
    v_lshrrev_b32 v49, 3, v7
    v_lshl_add_u32 v48, v49, 2, v48
    v_lshlrev_b32 v48, 2, v48
    v_lshl_add_u32 v48, v6, 10, v48
    v_add_u32 v48, s23, v48
    v_add_u32 v49, 2048, v48
    v_add_u32 v50, 4096, v48
    v_add_u32 v51, 6144, v48
    s_mov_b32 s56, 0x05040100
    s_mov_b32 s57, 0x07060302
    s_mov_b32 s58, 0xbfb8aa3b
    s_mov_b32 s59, s58
    s_mov_b32 s60, 0xffff0000
    s_brev_b32 s61, 1
    v_mov_b32 v62, 1
    s_waitcnt vmcnt(4)
    s_waitcnt lgkmcnt(0)
    s_mov_b64 exec, 1
    ds_add_u32 v61, v62 offset:1168
LS_W:
    ds_read_b32 v60, v61 offset:1168
    s_waitcnt lgkmcnt(0)
    v_readfirstlane_b32 s53, v60
    s_cmp_ge_u32 s53, 3
    s_cbranch_scc1 LSX_W
    s_sleep 1
    s_branch LS_W
LSX_W:
    s_mov_b64 exec, -1
    ds_read2_b32 v[96:97], v48 offset0:0 offset1:32
    ds_read2_b32 v[98:99], v48 offset0:64 offset1:96
    ds_read2_b32 v[100:101], v48 offset0:128 offset1:160
    ds_read2_b32 v[102:103], v48 offset0:192 offset1:224
    ds_read2_b32 v[104:105], v49 offset0:0 offset1:32
    ds_read2_b32 v[106:107], v49 offset0:64 offset1:96
    ds_read2_b32 v[108:109], v49 offset0:128 offset1:160
    ds_read2_b32 v[110:111], v49 offset0:192 offset1:224
    ds_read2_b32 v[112:113], v50 offset0:0 offset1:32
    ds_read2_b32 v[114:115], v50 offset0:64 offset1:96
    ds_read2_b32 v[116:117], v50 offset0:128 offset1:160
    ds_read2_b32 v[118:119], v50 offset0:192 offset1:224
    s_waitcnt lgkmcnt(8)
    ds_read2_b32 v[120:121], v51 offset0:0 offset1:32
    ds_read2_b32 v[122:123], v51 offset0:64 offset1:96
    ds_read2_b32 v[124:125], v51 offset0:128 offset1:160
    ds_read2_b32 v[126:127], v51 offset0:192 offset1:224
    s_waitcnt lgkmcnt(12)
    v_perm_b32 v8, v97, v96, s56
    v_perm_b32 v12, v97, v96, s57
    v_perm_b32 v9, v99, v98, s56
    v_perm_b32 v13, v99, v98, s57
    v_perm_b32 v10, v101, v100, s56
    v_perm_b32 v14, v101, v100, s57
    v_perm_b32 v11, v103, v102, s56
    v_perm_b32 v15, v103, v102, s57
    s_waitcnt lgkmcnt(8)
    v_perm_b32 v16, v105, v104, s56
    v_perm_b32 v20, v105, v104, s57
    v_perm_b32 v17, v107, v106, s56
    v_perm_b32 v21, v107, v106, s57
    v_perm_b32 v18, v109, v108, s56
    v_perm_b32 v22, v109, v108, s57
    v_perm_b32 v19, v111, v110, s56
    v_perm_b32 v23, v111, v110, s57
    s_waitcnt lgkmcnt(4)
    v_perm_b32 v24, v113, v112, s56
    v_perm_b32 v28, v113, v112, s57
    v_perm_b32 v25, v115, v114, s56
    v_perm_b32 v29, v115, v114, s57
    v_perm_b32 v26, v117, v116, s56
    v_perm_b32 v30, v117, v116, s57
    v_perm_b32 v27, v119, v118, s56
    v_perm_b32 v31, v119, v118, s57
    s_waitcnt lgkmcnt(0)
    v_perm_b32 v32, v121, v120, s56
    v_perm_b32 v36, v121, v120, s57
    v_perm_b32 v33, v123, v122, s56
    v_perm_b32 v37, v123, v122, s57
    v_perm_b32 v34, v125, v124, s56
    v_perm_b32 v38, v125, v124, s57
    v_perm_b32 v35, v127, v126, s56
    v_perm_b32 v39, v127, v126, s57
    s_waitcnt vmcnt(0)
    ds_read_b128 v[72:75], v44
    ds_read_b128 v[76:79], v45
    ds_read_b128 v[80:83], v46
    ds_read_b128 v[84:87], v47
    s_waitcnt lgkmcnt(3)
    v_mfma_f32_32x32x16_bf16 v[96:111], v[8:11], v[72:75], 0
    v_mfma_f32_32x32x16_bf16 v[112:127], v[12:15], v[72:75], 0
    s_waitcnt lgkmcnt(2)
    v_mfma_f32_32x32x16_bf16 v[96:111], v[16:19], v[76:79], v[96:111]
    v_mfma_f32_32x32x16_bf16 v[112:127], v[20:23], v[76:79], v[112:127]
    s_waitcnt lgkmcnt(1)
    v_mfma_f32_32x32x16_bf16 v[96:111], v[24:27], v[80:83], v[96:111]
    v_mfma_f32_32x32x16_bf16 v[112:127], v[28:31], v[80:83], v[112:127]
    s_waitcnt lgkmcnt(0)
    v_mfma_f32_32x32x16_bf16 v[96:111], v[32:35], v[84:87], v[96:111]
    v_mfma_f32_32x32x16_bf16 v[112:127], v[36:39], v[84:87], v[112:127]
    v_mov_b32 v7, 0
    s_nop 7
    s_nop 3
    v_pk_mul_f32 v[96:97], v[96:97], s[58:59]
    v_pk_mul_f32 v[98:99], v[98:99], s[58:59]
    v_pk_mul_f32 v[100:101], v[100:101], s[58:59]
    v_pk_mul_f32 v[102:103], v[102:103], s[58:59]
    v_pk_mul_f32 v[104:105], v[104:105], s[58:59]
    v_pk_mul_f32 v[106:107], v[106:107], s[58:59]
    v_pk_mul_f32 v[108:109], v[108:109], s[58:59]
    v_pk_mul_f32 v[110:111], v[110:111], s[58:59]
    v_pk_mul_f32 v[112:113], v[112:113], s[58:59]
    v_pk_mul_f32 v[114:115], v[114:115], s[58:59]
    v_pk_mul_f32 v[116:117], v[116:117], s[58:59]
    v_pk_mul_f32 v[118:119], v[118:119], s[58:59]
    v_pk_mul_f32 v[120:121], v[120:121], s[58:59]
    v_pk_mul_f32 v[122:123], v[122:123], s[58:59]
    v_pk_mul_f32 v[124:125], v[124:125], s[58:59]
    v_pk_mul_f32 v[126:127], v[126:127], s[58:59]
    v_cvt_pk_bf16_f32 v48, v96, v96
    v_and_b32 v39, 0x7fffffff, v112
    v_add_u32 v39, 0x8000, v39
    v_sub_u32_sdwa v39, v39, v48 clamp dst_sel:DWORD dst_unused:UNUSED_PAD src0_sel:DWORD src1_sel:WORD_0
    v_max3_f32 v7, |v96|, |v112|, v7
    v_bfi_b32 v39, s61, v112, v39
    v_bfi_b32 v48, s60, v39, v48
    v_cvt_pk_bf16_f32 v49, v97, v97
    v_and_b32 v39, 0x7fffffff, v113
    v_add_u32 v39, 0x8000, v39
    v_sub_u32_sdwa v39, v39, v49 clamp dst_sel:DWORD dst_unused:UNUSED_PAD src0_sel:DWORD src1_sel:WORD_0
    v_max3_f32 v7, |v97|, |v113|, v7
    v_bfi_b32 v39, s61, v113, v39
    v_bfi_b32 v49, s60, v39, v49
    v_cvt_pk_bf16_f32 v50, v98, v98
    v_and_b32 v39, 0x7fffffff, v114
    v_add_u32 v39, 0x8000, v39
    v_sub_u32_sdwa v39, v39, v50 clamp dst_sel:DWORD dst_unused:UNUSED_PAD src0_sel:DWORD src1_sel:WORD_0
    v_max3_f32 v7, |v98|, |v114|, v7
    v_bfi_b32 v39, s61, v114, v39
    v_bfi_b32 v50, s60, v39, v50
    v_cvt_pk_bf16_f32 v51, v99, v99
    v_and_b32 v39, 0x7fffffff, v115
    v_add_u32 v39, 0x8000, v39
    v_sub_u32_sdwa v39, v39, v51 clamp dst_sel:DWORD dst_unused:UNUSED_PAD src0_sel:DWORD src1_sel:WORD_0
    v_max3_f32 v7, |v99|, |v115|, v7
    v_bfi_b32 v39, s61, v115, v39
    v_bfi_b32 v51, s60, v39, v51
    ds_write_b128 v40, v[48:51]
    v_cvt_pk_bf16_f32 v52, v100, v100
    v_and_b32 v39, 0x7fffffff, v116
    v_add_u32 v39, 0x8000, v39
    v_sub_u32_sdwa v39, v39, v52 clamp dst_sel:DWORD dst_unused:UNUSED_PAD src0_sel:DWORD src1_sel:WORD_0
    v_max3_f32 v7, |v100|, |v116|, v7
    v_bfi_b32 v39, s61, v116, v39
    v_bfi_b32 v52, s60, v39, v52
    v_cvt_pk_bf16_f32 v53, v101, v101
    v_and_b32 v39, 0x7fffffff, v117
    v_add_u32 v39, 0x8000, v39
    v_sub_u32_sdwa v39, v39, v53 clamp dst_sel:DWORD dst_unused:UNUSED_PAD src0_sel:DWORD src1_sel:WORD_0
    v_max3_f32 v7, |v101|, |v117|, v7
    v_bfi_b32 v39, s61, v117, v39
    v_bfi_b32 v53, s60, v39, v53
    v_cvt_pk_bf16_f32 v54, v102, v102
    v_and_b32 v39, 0x7fffffff, v118
    v_add_u32 v39, 0x8000, v39
    v_sub_u32_sdwa v39, v39, v54 clamp dst_sel:DWORD dst_unused:UNUSED_PAD src0_sel:DWORD src1_sel:WORD_0
    v_max3_f32 v7, |v102|, |v118|, v7
    v_bfi_b32 v39, s61, v118, v39
    v_bfi_b32 v54, s60, v39, v54
    v_cvt_pk_bf16_f32 v55, v103, v103
    v_and_b32 v39, 0x7fffffff, v119
    v_add_u32 v39, 0x8000, v39
    v_sub_u32_sdwa v39, v39, v55 clamp dst_sel:DWORD dst_unused:UNUSED_PAD src0_sel:DWORD src1_sel:WORD_0
    v_max3_f32 v7, |v103|, |v119|, v7
    v_bfi_b32 v39, s61, v119, v39
    v_bfi_b32 v55, s60, v39, v55
    ds_write_b128 v41, v[52:55]
    v_cvt_pk_bf16_f32 v56, v104, v104
    v_and_b32 v39, 0x7fffffff, v120
    v_add_u32 v39, 0x8000, v39
    v_sub_u32_sdwa v39, v39, v56 clamp dst_sel:DWORD dst_unused:UNUSED_PAD src0_sel:DWORD src1_sel:WORD_0
    v_max3_f32 v7, |v104|, |v120|, v7
    v_bfi_b32 v39, s61, v120, v39
    v_bfi_b32 v56, s60, v39, v56
    v_cvt_pk_bf16_f32 v57, v105, v105
    v_and_b32 v39, 0x7fffffff, v121
    v_add_u32 v39, 0x8000, v39
    v_sub_u32_sdwa v39, v39, v57 clamp dst_sel:DWORD dst_unused:UNUSED_PAD src0_sel:DWORD src1_sel:WORD_0
    v_max3_f32 v7, |v105|, |v121|, v7
    v_bfi_b32 v39, s61, v121, v39
    v_bfi_b32 v57, s60, v39, v57
    v_cvt_pk_bf16_f32 v58, v106, v106
    v_and_b32 v39, 0x7fffffff, v122
    v_add_u32 v39, 0x8000, v39
    v_sub_u32_sdwa v39, v39, v58 clamp dst_sel:DWORD dst_unused:UNUSED_PAD src0_sel:DWORD src1_sel:WORD_0
    v_max3_f32 v7, |v106|, |v122|, v7
    v_bfi_b32 v39, s61, v122, v39
    v_bfi_b32 v58, s60, v39, v58
    v_cvt_pk_bf16_f32 v59, v107, v107
    v_and_b32 v39, 0x7fffffff, v123
    v_add_u32 v39, 0x8000, v39
    v_sub_u32_sdwa v39, v39, v59 clamp dst_sel:DWORD dst_unused:UNUSED_PAD src0_sel:DWORD src1_sel:WORD_0
    v_max3_f32 v7, |v107|, |v123|, v7
    v_bfi_b32 v39, s61, v123, v39
    v_bfi_b32 v59, s60, v39, v59
    ds_write_b128 v42, v[56:59]
    v_cvt_pk_bf16_f32 v60, v108, v108
    v_and_b32 v39, 0x7fffffff, v124
    v_add_u32 v39, 0x8000, v39
    v_sub_u32_sdwa v39, v39, v60 clamp dst_sel:DWORD dst_unused:UNUSED_PAD src0_sel:DWORD src1_sel:WORD_0
    v_max3_f32 v7, |v108|, |v124|, v7
    v_bfi_b32 v39, s61, v124, v39
    v_bfi_b32 v60, s60, v39, v60
    v_cvt_pk_bf16_f32 v61, v109, v109
    v_and_b32 v39, 0x7fffffff, v125
    v_add_u32 v39, 0x8000, v39
    v_sub_u32_sdwa v39, v39, v61 clamp dst_sel:DWORD dst_unused:UNUSED_PAD src0_sel:DWORD src1_sel:WORD_0
    v_max3_f32 v7, |v109|, |v125|, v7
    v_bfi_b32 v39, s61, v125, v39
    v_bfi_b32 v61, s60, v39, v61
    v_cvt_pk_bf16_f32 v62, v110, v110
    v_and_b32 v39, 0x7fffffff, v126
    v_add_u32 v39, 0x8000, v39
    v_sub_u32_sdwa v39, v39, v62 clamp dst_sel:DWORD dst_unused:UNUSED_PAD src0_sel:DWORD src1_sel:WORD_0
    v_max3_f32 v7, |v110|, |v126|, v7
    v_bfi_b32 v39, s61, v126, v39
    v_bfi_b32 v62, s60, v39, v62
    v_cvt_pk_bf16_f32 v63, v111, v111
    v_and_b32 v39, 0x7fffffff, v127
    v_add_u32 v39, 0x8000, v39
    v_sub_u32_sdwa v39, v39, v63 clamp dst_sel:DWORD dst_unused:UNUSED_PAD src0_sel:DWORD src1_sel:WORD_0
    v_max3_f32 v7, |v111|, |v127|, v7
    v_bfi_b32 v39, s61, v127, v39
    v_bfi_b32 v63, s60, v39, v63
    ds_write_b128 v43, v[60:63]
    v_cmp_ngt_f32 vcc, 0x41200000, v7
    s_mov_b64 s[82:83], vcc
    s_mov_b64 s[40:41], s[14:15]
    s_mov_b32 s42, 16384
    s_mov_b32 s43, 0x20000
    v_lshlrev_b32 v124, 4, v0
    s_lshl_b32 s52, s22, 10
    s_add_u32 s53, s52, 1792
    s_mov_b32 m0, s53
    v_add_u32 v125, 0x2000, v124
    buffer_load_dwordx4 v124, s[40:43], 0 offen lds
    s_add_u32 s53, s52, 18176
    s_mov_b32 m0, s53
    v_lshlrev_b32 v126, 1, v0
    v_and_b32 v126, 0x70, v126
    buffer_load_dwordx4 v125, s[36:39], 0 offen lds
    v_xor_b32 v126, v126, v124
    s_mul_i32 s90, s89, 12544
    v_add_u32 v126, s90, v126
    s_and_b32 s53, s22, 14
    s_cmp_lg_u32 s53, 12
    s_cbranch_scc1 BD_2
    s_add_u32 s53, s52, 130688
    s_mov_b32 m0, s53
    s_nop 0
    buffer_load_dwordx4 v126, s[24:27], 0 offen lds
BD_2:
    s_waitcnt lgkmcnt(0)
    ds_read_b128 v[64:67], v5 offset:0
    ds_read_b128 v[68:71], v5 offset:1024
    ds_read_b128 v[72:75], v5 offset:2048
    ds_read_b128 v[76:79], v5 offset:3072
    s_waitcnt lgkmcnt(3)
    buffer_store_dwordx4 v[64:67], v92, s[28:31], 0 offen offset:0 sc1
    s_waitcnt lgkmcnt(2)
    buffer_store_dwordx4 v[68:71], v93, s[28:31], 0 offen offset:1024 sc1
    s_waitcnt lgkmcnt(1)
    buffer_store_dwordx4 v[72:75], v94, s[28:31], 0 offen offset:2048 sc1
    s_waitcnt lgkmcnt(0)
    buffer_store_dwordx4 v[76:79], v95, s[28:31], 0 offen offset:3072 sc1
PH1_DONE:
    v_mov_b32 v6, 0
    v_mov_b32 v7, 1
    s_cmp_eq_u64 s[82:83], 0
    s_cbranch_scc1 V1
    ds_write_b32 v6, v7 offset:1152
V1:
    s_mov_b64 s[32:33], s[20:21]
    s_mov_b32 s34, 9961472
    s_mov_b32 s35, 0x20000
    s_mov_b64 s[28:29], s[20:21]
    s_mov_b32 s30, 3200000
    s_mov_b32 s31, 0x20000
    s_lshr_b32 s86, s22, 1
    s_and_b32 s87, s22, 1
    s_lshl_b32 s3, s86, 11
    s_add_u32 s88, s90, s3
    s_movk_i32 s78, 0x3f80
    s_movk_i32 s50, 272
    s_mov_b32 s79, 0xffffff
    s_mov_b32 s23, 0
    s_mov_b32 s49, 0
    s_mov_b32 s48, 32
    s_mov_b32 s93, 3276800
    v_and_b32 v40, 3, v0
    v_bfe_u32 v41, v0, 2, 2
    v_bfe_u32 v42, v0, 4, 2
    v_lshlrev_b32 v42, 10, v42
    v_lshl_add_u32 v42, v41, 4, v42
    v_lshl_add_u32 v43, v40, 1, v42
    v_lshl_add_u32 v42, v40, 2, v42
    s_lshr_b32 s52, s22, 3
    s_lshl_b32 s52, s52, 6
    s_bfe_u32 s53, s22, 0x10002
    s_lshl_b32 s53, s53, 3
    s_add_u32 s52, s52, s53
    s_and_b32 s53, s22, 3
    s_lshl_b32 s53, s53, 12
    s_add_u32 s52, s52, s53
    v_add_u32 v43, s52, v43
    s_bfe_u32 s52, s22, 0x10002
    s_lshl_b32 s52, s52, 6
    s_bfe_u32 s53, s22, 0x10001
    s_lshl_b32 s53, s53, 1
    s_sub_u32 s52, s52, s53
    s_add_u32 s52, s52, 2
    s_and_b32 s53, s22, 1
    s_lshl_b32 s53, s53, 12
    s_add_u32 s52, s52, s53
    v_add_u32 v42, s52, v42
    v_and_b32 v1, 7, v0
    v_lshlrev_b32 v1, 4, v1
    s_waitcnt vmcnt(0) lgkmcnt(0)
    s_barrier
    s_cmp_lg_u32 s22, 12
    s_cbranch_scc1 NODESC
    ds_read_b128 v[44:47], v6 offset:1152
    v_and_b32 v19, 63, v0
    v_lshlrev_b32 v19, 12, v19
    s_lshl_b32 s52, s2, 4
    s_add_u32 s52, s52, 9699328
    s_waitcnt lgkmcnt(0)
    v_lshl_or_b32 v21, v44, 31, v21
    v_mov_b32 v22, v46
    v_mov_b32 v23, v47
    buffer_store_dwordx4 v[20:23], v19, s[32:35], s52 offen sc1
NODESC:
    ds_read_u16 v56, v43 offset:1792
    ds_read_u16 v57, v43 offset:1920
    ds_read_u16 v58, v43 offset:2048
    ds_read_u16 v59, v43 offset:2176
    ds_read_u16 v60, v43 offset:2304
    ds_read_u16 v61, v43 offset:2432
    ds_read_u16 v62, v43 offset:2560
    ds_read_u16 v63, v43 offset:2688
    ds_read_b128 v[120:123], v1 offset:26368
    s_cmp_gt_u32 s22, 7
    s_cbranch_scc1 NOW2
    s_waitcnt lgkmcnt(4)
    ds_read_u16 v64, v42 offset:18176
    ds_read_u16 v65, v42 offset:18304
    ds_read_u16 v66, v42 offset:18432
    ds_read_u16 v67, v42 offset:18560
    ds_read_u16 v68, v42 offset:18688
    ds_read_u16 v69, v42 offset:18816
    ds_read_u16 v70, v42 offset:18944
    ds_read_u16 v71, v42 offset:19072
    s_waitcnt lgkmcnt(0)
    v_lshl_or_b32 v76, v65, 16, v64
    v_lshl_or_b32 v77, v67, 16, v66
    v_lshl_or_b32 v78, v69, 16, v68
    v_lshl_or_b32 v79, v71, 16, v70
    ds_write_b128 v124, v[76:79] offset:38656
NOW2:
    v_add_u32 v125, 145024, v124
    s_mov_b32 s90, 0xbfb8aa3b
    s_mov_b32 s91, s90
    s_waitcnt lgkmcnt(0)
    v_lshl_or_b32 v72, v57, 16, v56
    v_lshl_or_b32 v73, v59, 16, v58
    v_lshl_or_b32 v74, v61, 16, v60
    v_lshl_or_b32 v75, v63, 16, v62
    ds_write_b128 v125, v[72:75]
    v_and_b32 v8, 0xffff0000, v120
    v_lshlrev_b32 v12, 16, v120
    v_and_b32 v9, 0xffff0000, v121
    v_lshlrev_b32 v13, 16, v121
    v_and_b32 v10, 0xffff0000, v122
    v_lshlrev_b32 v14, 16, v122
    v_and_b32 v11, 0xffff0000, v123
    v_lshlrev_b32 v15, 16, v123
    v_pk_mul_f32 v[8:9], v[8:9], s[90:91]
    v_pk_mul_f32 v[10:11], v[10:11], s[90:91]
    v_pk_mul_f32 v[12:13], v[12:13], s[90:91]
    v_pk_mul_f32 v[14:15], v[14:15], s[90:91]
    v_add_u32 v2, 100128, v1
    v_lshrrev_b32 v125, 3, v0
    v_mov_b32 v3, 4294905824
    v_mad_u32_u24 v3, v125, s50, v3
    v_and_b32 v72, 63, v0
    v_lshlrev_b32 v72, 4, v72
    s_lshl_b32 s52, s87, 12
    v_add_u32 v72, s52, v72
    v_and_b32 v73, 15, v0
    s_lshl_b32 s52, s86, 4
    v_add_u32 v73, s52, v73
    v_and_b32 v74, 48, v0
    v_lshlrev_b32 v75, 4, v0
    v_and_b32 v75, 0x70, v75
    v_xor_b32 v75, v75, v74
    v_lshl_add_u32 v75, v73, 7, v75
    v_add_u32 v75, 130688, v75
    v_xor_b32 v76, 64, v75
    v_mad_u32_u24 v73, v73, s50, v74
    s_lshl_b32 s3, s87, 6
    s_add_u32 s3, s3, 100128
    v_add_u32 v73, s3, v73
    s_waitcnt lgkmcnt(0)
    s_barrier
    s_mov_b64 s[82:83], 0
    s_cmp_ge_u32 s22, 14
    s_cbranch_scc1 NOQ
    ds_read_b128 v[88:91], v75
    ds_read_b128 v[96:99], v72 offset:38656
    ds_read_b128 v[104:107], v72 offset:40704
    ds_read_b128 v[92:95], v76
    ds_read_b128 v[100:103], v72 offset:39680
    ds_read_b128 v[108:111], v72 offset:41728
    s_waitcnt lgkmcnt(3)
    v_mfma_f32_16x16x32_bf16 v[112:115], v[96:99], v[88:91], 0
    v_mfma_f32_16x16x32_bf16 v[116:119], v[104:107], v[88:91], 0
    s_waitcnt lgkmcnt(0)
    v_mfma_f32_16x16x32_bf16 v[112:115], v[100:103], v[92:95], v[112:115]
    v_mfma_f32_16x16x32_bf16 v[116:119], v[108:111], v[92:95], v[116:119]
    s_nop 7
    v_pk_mul_f32 v[112:113], v[112:113], s[90:91]
    v_pk_mul_f32 v[114:115], v[114:115], s[90:91]
    v_pk_mul_f32 v[116:117], v[116:117], s[90:91]
    v_pk_mul_f32 v[118:119], v[118:119], s[90:91]
    ds_write_b128 v73, v[112:115]
    ds_write_b128 v73, v[116:119] offset:128
    v_max3_f32 v125, |v112|, |v113|, |v114|
    v_max3_f32 v125, |v115|, |v116|, v125
    v_max3_f32 v125, |v117|, |v118|, v125
    v_max_f32 v125, |v119|, v125
    v_cmp_ngt_f32 vcc, 0x41200000, v125
    s_cmp_eq_u64 vcc, 0
    s_cbranch_scc1 NOQV
    ds_write_b32 v6, v7 offset:1152
NOQV:
    v_exp_f32 v24, v112
    v_exp_f32 v25, v113
    v_exp_f32 v26, v114
    v_exp_f32 v27, v115
    v_exp_f32 v28, v116
    v_exp_f32 v29, v117
    v_exp_f32 v30, v118
    v_exp_f32 v31, v119
    s_nop 0
    v_pk_add_f32 v[24:25], v[24:25], 1.0 op_sel_hi:[1,0]
    v_pk_add_f32 v[26:27], v[26:27], 1.0 op_sel_hi:[1,0]
    v_pk_add_f32 v[28:29], v[28:29], 1.0 op_sel_hi:[1,0]
    v_pk_add_f32 v[30:31], v[30:31], 1.0 op_sel_hi:[1,0]
    v_rcp_f32 v24, v24
    v_rcp_f32 v25, v25
    v_rcp_f32 v26, v26
    v_rcp_f32 v27, v27
    v_rcp_f32 v28, v28
    v_rcp_f32 v29, v29
    v_rcp_f32 v30, v30
    v_rcp_f32 v31, v31
    s_nop 0
    v_pk_mul_f32 v[24:25], v[24:25], v[112:113]
    v_pk_mul_f32 v[26:27], v[26:27], v[114:115]
    v_pk_mul_f32 v[28:29], v[28:29], v[116:117]
    v_pk_mul_f32 v[30:31], v[30:31], v[118:119]
NOQ:
    v_mov_b32 v120, 0x62ffff80
    v_mov_b32 v121, 0
    v_mov_b32 v122, v120
    v_mov_b32 v123, 0
    v_lshlrev_b32 v124, 4, v0
    ds_write_b128 v124, v[120:123] offset:1792
    ds_write_b128 v124, v[120:123] offset:18176
    s_cmp_gt_u32 s22, 3
    s_cbranch_scc1 K2_PF1_0
    ds_write_b128 v124, v[120:123] offset:34560
K2_PF1_0:
    s_cmp_lg_u32 s22, 15
    s_cbranch_scc1 K2_PF2_0
    v_and_b32 v125, 63, v0
    v_lshlrev_b32 v125, 3, v125
    v_mov_b32 v120, 0
    ds_write_b64 v125, v[120:121] offset:0
    ds_write_b32 v121, v120 offset:1156
K2_PF2_0:
    v_and_b32 v7, 15, v0
    v_add_u32 v6, 16, v7
    v_lshrrev_b32 v72, 2, v0
    v_and_b32 v72, 0xfc, v72
    s_cmp_lg_u32 s22, 15
    s_cbranch_scc1 DSKIP
    ds_read_b64 v[74:75], v121 offset:1160
    v_lshlrev_b32 v76, 1, v125
    s_lshr_b32 s3, s89, 2
    s_lshl_b32 s3, s3, 12
    s_add_u32 s3, s3, 9699328
    s_and_b32 s53, s89, 3
    s_mul_i32 s54, s53, 12
    s_cmp_eq_u32 s53, 3
    s_cselect_b32 s54, 4, s54
    v_mul_u32_u24 v73, 200, v76
    s_mov_b64 s[56:57], 0
    s_mov_b64 s[58:59], 0
    s_mov_b64 s[60:61], 0
    s_mov_b64 s[62:63], 0
    s_mov_b32 s52, 65536
    s_waitcnt lgkmcnt(0)
DPOLL:
    s_not_b64 exec, s[56:57]
    s_cbranch_execz DP0
    buffer_load_dwordx4 v[56:59], v76, s[32:35], s3 offen offset:0 sc1
DP0:
    s_not_b64 exec, s[58:59]
    s_cbranch_execz DP1
    buffer_load_dwordx4 v[60:63], v76, s[32:35], s3 offen offset:1024 sc1
DP1:
    s_not_b64 exec, s[60:61]
    s_cbranch_execz DP2
    buffer_load_dwordx4 v[64:67], v76, s[32:35], s3 offen offset:2048 sc1
DP2:
    s_not_b64 exec, s[62:63]
    s_cbranch_execz DP3
    buffer_load_dwordx4 v[68:71], v76, s[32:35], s3 offen offset:3072 sc1
DP3:
    s_mov_b64 exec, -1
    s_waitcnt vmcnt(0)
    v_cmp_eq_u64 s[56:57], v[74:75], v[58:59]
    v_cmp_eq_u64 s[58:59], v[74:75], v[62:63]
    v_cmp_eq_u64 s[60:61], v[74:75], v[66:67]
    v_cmp_eq_u64 s[62:63], v[74:75], v[70:71]
    s_and_b64 s[64:65], s[56:57], s[58:59]
    s_and_b64 s[66:67], s[60:61], s[62:63]
    s_and_b64 s[64:65], s[64:65], s[66:67]
    s_cmp_eq_u64 s[64:65], -1
    s_cbranch_scc1 DOK
    s_sub_u32 s52, s52, 1
    s_cmp_eq_u32 s52, 0
    s_cbranch_scc1 DOK
    s_sleep 2
    s_branch DPOLL
DOK:
    s_cmp_lg_u32 s2, 0
    s_cbranch_scc1 DNC
    v_mov_b32 v77, 0
    v_mov_b64 v[78:79], 0
    s_mov_b64 exec, 1
    global_store_dwordx2 v77, v[78:79], s[18:19] offset:248 sc1
    s_mov_b64 exec, -1
DNC:
    v_or3_b32 v77, v57, v61, v65
    v_or_b32 v77, v77, v69
    v_cmp_gt_i32 vcc, 0, v77
    s_cmp_eq_u64 vcc, 0
    s_cbranch_scc1 DNF
    v_mov_b32 v77, 1
    ds_write_b32 v121, v77 offset:1152
DNF:
    s_cmp_lg_u32 s53, 3
    s_cbranch_scc1 DK3
    v_mov_b32 v56, v57
    v_mov_b32 v60, v61
    v_mov_b32 v64, v65
    v_mov_b32 v68, v69
DK3:
    v_lshrrev_b32 v76, 2, v76
    v_alignbit_b32 v56, v57, v56, s54
    v_bfe_u32 v57, v56, 12, 12
    v_and_b32 v56, 0xfff, v56
    v_sub_u32 v57, v57, v56
    v_add_u32 v56, v56, v73
    v_lshl_or_b32 v56, v57, 20, v56
    ds_write_b32 v76, v56 offset:47104
    v_alignbit_b32 v60, v61, v60, s54
    v_bfe_u32 v61, v60, 12, 12
    v_and_b32 v60, 0xfff, v60
    v_sub_u32 v61, v61, v60
    v_add_u32 v60, v60, v73
    v_add_u32 v60, 204800, v60
    v_lshl_or_b32 v60, v61, 20, v60
    ds_write_b32 v76, v60 offset:47360
    v_alignbit_b32 v64, v65, v64, s54
    v_bfe_u32 v65, v64, 12, 12
    v_and_b32 v64, 0xfff, v64
    v_sub_u32 v65, v65, v64
    v_add_u32 v64, v64, v73
    v_add_u32 v64, 409600, v64
    v_lshl_or_b32 v64, v65, 20, v64
    ds_write_b32 v76, v64 offset:47616
    v_alignbit_b32 v68, v69, v68, s54
    v_bfe_u32 v69, v68, 12, 12
    v_and_b32 v68, 0xfff, v68
    v_sub_u32 v69, v69, v68
    v_add_u32 v68, v68, v73
    v_add_u32 v68, 614400, v68
    v_lshl_or_b32 v68, v69, 20, v68
    ds_write_b32 v76, v68 offset:47872
DSKIP:
    s_waitcnt lgkmcnt(0)
    s_barrier
    ds_read2st64_b32 v[32:33], v72 offset0:184 offset1:185
    ds_read2st64_b32 v[34:35], v72 offset0:186 offset1:187
    s_waitcnt lgkmcnt(0)
K2_ROUND:
    s_add_u32 s90, s23, s48
    s_mov_b32 s3, 0xfffff
    s_mov_b32 s52, 6553600
    v_lshrrev_b32 v80, 20, v32
    v_and_b32 v84, s3, v32
    v_cmp_lt_u32 s[56:57], v7, v80
    v_cmp_lt_u32 s[58:59], v6, v80
    v_add_u32 v84, v84, v7
    v_lshlrev_b32 v85, 2, v84
    s_mov_b64 exec, s[56:57]
    buffer_load_ubyte v56, v84, s[32:35], s52 offen sc1
    buffer_load_dword v57, v85, s[32:35], s93 offen sc1
    s_mov_b64 exec, s[58:59]
    s_cbranch_execz K2_T2_0
    buffer_load_ubyte v58, v84, s[32:35], s52 offen offset:16 sc1
    buffer_load_dword v59, v85, s[32:35], s93 offen offset:64 sc1
K2_T2_0:
    s_mov_b64 exec, -1
    v_lshrrev_b32 v81, 20, v33
    v_and_b32 v84, s3, v33
    v_cmp_lt_u32 s[60:61], v7, v81
    v_cmp_lt_u32 s[62:63], v6, v81
    v_add_u32 v84, v84, v7
    v_lshlrev_b32 v85, 2, v84
    s_mov_b64 exec, s[60:61]
    buffer_load_ubyte v60, v84, s[32:35], s52 offen sc1
    buffer_load_dword v61, v85, s[32:35], s93 offen sc1
    s_mov_b64 exec, s[62:63]
    s_cbranch_execz K2_T2_1
    buffer_load_ubyte v62, v84, s[32:35], s52 offen offset:16 sc1
    buffer_load_dword v63, v85, s[32:35], s93 offen offset:64 sc1
K2_T2_1:
    s_mov_b64 exec, -1
    v_lshrrev_b32 v82, 20, v34
    v_and_b32 v84, s3, v34
    v_cmp_lt_u32 s[64:65], v7, v82
    v_cmp_lt_u32 s[66:67], v6, v82
    v_add_u32 v84, v84, v7
    v_lshlrev_b32 v85, 2, v84
    s_mov_b64 exec, s[64:65]
    buffer_load_ubyte v64, v84, s[32:35], s52 offen sc1
    buffer_load_dword v65, v85, s[32:35], s93 offen sc1
    s_mov_b64 exec, s[66:67]
    s_cbranch_execz K2_T2_2
    buffer_load_ubyte v66, v84, s[32:35], s52 offen offset:16 sc1
    buffer_load_dword v67, v85, s[32:35], s93 offen offset:64 sc1
K2_T2_2:
    s_mov_b64 exec, -1
    v_lshrrev_b32 v83, 20, v35
    v_and_b32 v84, s3, v35
    v_cmp_lt_u32 s[68:69], v7, v83
    v_cmp_lt_u32 s[70:71], v6, v83
    v_add_u32 v84, v84, v7
    v_lshlrev_b32 v85, 2, v84
    s_mov_b64 exec, s[68:69]
    buffer_load_ubyte v68, v84, s[32:35], s52 offen sc1
    buffer_load_dword v69, v85, s[32:35], s93 offen sc1
    s_mov_b64 exec, s[70:71]
    s_cbranch_execz K2_T2_3
    buffer_load_ubyte v70, v84, s[32:35], s52 offen offset:16 sc1
    buffer_load_dword v71, v85, s[32:35], s93 offen offset:64 sc1
K2_T2_3:
    s_mov_b64 exec, -1
    v_max3_u32 v80, v80, v81, v82
    v_max_u32 v80, v80, v83
    v_cmp_lt_u32 s[54:55], s90, v80
    v_mov_b32 v7, 1
    v_mov_b32 v6, 0
    s_cmp_eq_u64 s[54:55], 0
    s_cbranch_scc1 K2_F2
    ds_write_b32 v6, v7 offset:1156
K2_F2:
    v_and_b32 v5, 63, v0
    v_lshlrev_b32 v5, 3, v5
    s_movk_i32 s3, 1792
    s_waitcnt vmcnt(0)
    v_lshlrev_b32 v100, 2, v56
    v_lshlrev_b32 v101, 2, v58
    v_lshlrev_b32 v102, 2, v60
    v_lshlrev_b32 v103, 2, v62
    v_lshlrev_b32 v104, 2, v64
    v_lshlrev_b32 v105, 2, v66
    v_lshlrev_b32 v106, 2, v68
    v_lshlrev_b32 v107, 2, v70
    s_mov_b64 exec, s[56:57]
    ds_add_rtn_u32 v80, v100, v7 offset:0
    s_mov_b64 exec, s[58:59]
    s_cbranch_execz K2_RK1
    ds_add_rtn_u32 v81, v101, v7 offset:0
K2_RK1:
    s_mov_b64 exec, s[60:61]
    ds_add_rtn_u32 v82, v102, v7 offset:0
    s_mov_b64 exec, s[62:63]
    s_cbranch_execz K2_RK3
    ds_add_rtn_u32 v83, v103, v7 offset:0
K2_RK3:
    s_mov_b64 exec, s[64:65]
    ds_add_rtn_u32 v84, v104, v7 offset:0
    s_mov_b64 exec, s[66:67]
    s_cbranch_execz K2_RK5
    ds_add_rtn_u32 v85, v105, v7 offset:0
K2_RK5:
    s_mov_b64 exec, s[68:69]
    ds_add_rtn_u32 v86, v106, v7 offset:0
    s_mov_b64 exec, s[70:71]
    s_cbranch_execz K2_RK7
    ds_add_rtn_u32 v87, v107, v7 offset:0
K2_RK7:
    s_mov_b64 exec, -1
    v_lshlrev_b32_sdwa v108, 7, v57 dst_sel:DWORD dst_unused:UNUSED_PAD src0_sel:DWORD src1_sel:WORD_0
    v_and_b32 v57, 0xffff0000, v57
    v_lshl_or_b32 v56, v56, 24, v108
    v_lshlrev_b32_sdwa v108, 7, v59 dst_sel:DWORD dst_unused:UNUSED_PAD src0_sel:DWORD src1_sel:WORD_0
    v_and_b32 v59, 0xffff0000, v59
    v_lshl_or_b32 v58, v58, 24, v108
    v_lshlrev_b32_sdwa v108, 7, v61 dst_sel:DWORD dst_unused:UNUSED_PAD src0_sel:DWORD src1_sel:WORD_0
    v_and_b32 v61, 0xffff0000, v61
    v_lshl_or_b32 v60, v60, 24, v108
    v_lshlrev_b32_sdwa v108, 7, v63 dst_sel:DWORD dst_unused:UNUSED_PAD src0_sel:DWORD src1_sel:WORD_0
    v_and_b32 v63, 0xffff0000, v63
    v_lshl_or_b32 v62, v62, 24, v108
    v_lshlrev_b32_sdwa v108, 7, v65 dst_sel:DWORD dst_unused:UNUSED_PAD src0_sel:DWORD src1_sel:WORD_0
    v_and_b32 v65, 0xffff0000, v65
    v_lshl_or_b32 v64, v64, 24, v108
    v_lshlrev_b32_sdwa v108, 7, v67 dst_sel:DWORD dst_unused:UNUSED_PAD src0_sel:DWORD src1_sel:WORD_0
    v_and_b32 v67, 0xffff0000, v67
    v_lshl_or_b32 v66, v66, 24, v108
    v_lshlrev_b32_sdwa v108, 7, v69 dst_sel:DWORD dst_unused:UNUSED_PAD src0_sel:DWORD src1_sel:WORD_0
    v_and_b32 v69, 0xffff0000, v69
    v_lshl_or_b32 v68, v68, 24, v108
    v_lshlrev_b32_sdwa v108, 7, v71 dst_sel:DWORD dst_unused:UNUSED_PAD src0_sel:DWORD src1_sel:WORD_0
    v_and_b32 v71, 0xffff0000, v71
    v_lshl_or_b32 v70, v70, 24, v108
    s_waitcnt lgkmcnt(0)
    s_barrier
    ds_read_b64 v[88:89], v5 offset:0
    ds_read_b64 v[90:91], v6 offset:1152
    s_waitcnt lgkmcnt(1)
    v_add_u32 v92, 3, v88
    v_add_u32 v93, 3, v89
    v_lshrrev_b32 v92, 2, v92
    v_lshrrev_b32 v93, 2, v93
    v_add_u32 v94, v92, v93
    v_mov_b32 v95, v94
    s_nop 1
    v_add_u32_dpp v95, v95, v95 row_shr:1 row_mask:0xf bank_mask:0xf bound_ctrl:0
    s_nop 1
    v_add_u32_dpp v95, v95, v95 row_shr:2 row_mask:0xf bank_mask:0xf bound_ctrl:0
    s_nop 1
    v_add_u32_dpp v95, v95, v95 row_shr:4 row_mask:0xf bank_mask:0xf bound_ctrl:0
    s_nop 1
    v_add_u32_dpp v95, v95, v95 row_shr:8 row_mask:0xf bank_mask:0xf bound_ctrl:0
    s_nop 1
    v_add_u32_dpp v95, v95, v95 row_bcast:15 row_mask:0xa bank_mask:0xf
    s_nop 1
    v_add_u32_dpp v95, v95, v95 row_bcast:31 row_mask:0xc bank_mask:0xf
    v_sub_u32 v96, v95, v94
    v_add_u32 v97, v96, v92
    v_lshl_add_u32 v98, v96, 5, s3
    v_lshl_add_u32 v99, v97, 5, s3
    ds_write_b64 v5, v[98:99] offset:512
    v_readlane_b32 s72, v95, 63
    s_waitcnt lgkmcnt(0)
    s_mov_b64 exec, s[56:57]
    ds_read_b32 v100, v100 offset:512
    s_mov_b64 exec, s[58:59]
    s_cbranch_execz K2_OF1
    ds_read_b32 v101, v101 offset:512
K2_OF1:
    s_mov_b64 exec, s[60:61]
    ds_read_b32 v102, v102 offset:512
    s_mov_b64 exec, s[62:63]
    s_cbranch_execz K2_OF3
    ds_read_b32 v103, v103 offset:512
K2_OF3:
    s_mov_b64 exec, s[64:65]
    ds_read_b32 v104, v104 offset:512
    s_mov_b64 exec, s[66:67]
    s_cbranch_execz K2_OF5
    ds_read_b32 v105, v105 offset:512
K2_OF5:
    s_mov_b64 exec, s[68:69]
    ds_read_b32 v106, v106 offset:512
    s_mov_b64 exec, s[70:71]
    s_cbranch_execz K2_OF7
    ds_read_b32 v107, v107 offset:512
K2_OF7:
    s_mov_b64 exec, -1
    s_cmp_gt_u32 s72, 1140
    s_cbranch_scc1 K2_NARROW
    v_readfirstlane_b32 s84, v90
    v_readfirstlane_b32 s85, v91
    s_add_u32 s73, s72, 7
    s_lshr_b32 s73, s73, 3
    s_lshr_b32 s74, s73, 4
    s_and_b32 s75, s73, 15
    s_cmp_lt_u32 s22, s75
    s_cselect_b32 s76, 1, 0
    s_add_u32 s76, s76, s74
    s_mul_i32 s3, s74, s22
    s_min_u32 s90, s22, s75
    s_add_u32 s3, s3, s90
    s_lshl_b32 s3, s3, 8
    s_add_u32 s3, s3, 1792
    s_lshl_b32 s90, s76, 5
    v_bfe_u32 v7, v0, 3, 3
    v_mov_b32 v4, s3
    v_mad_u32_u24 v4, v7, s90, v4
    s_waitcnt lgkmcnt(0)
    v_lshl_add_u32 v100, v80, 3, v100
    v_lshl_add_u32 v101, v81, 3, v101
    v_lshl_add_u32 v102, v82, 3, v102
    v_lshl_add_u32 v103, v83, 3, v103
    v_lshl_add_u32 v104, v84, 3, v104
    v_lshl_add_u32 v105, v85, 3, v105
    v_lshl_add_u32 v106, v86, 3, v106
    v_lshl_add_u32 v107, v87, 3, v107
    s_mov_b64 exec, s[56:57]
    ds_write_b64 v100, v[56:57]
    s_mov_b64 exec, s[58:59]
    s_cbranch_execz K2_SC1
    ds_write_b64 v101, v[58:59]
K2_SC1:
    s_mov_b64 exec, s[60:61]
    ds_write_b64 v102, v[60:61]
    s_mov_b64 exec, s[62:63]
    s_cbranch_execz K2_SC3
    ds_write_b64 v103, v[62:63]
K2_SC3:
    s_mov_b64 exec, s[64:65]
    ds_write_b64 v104, v[64:65]
    s_mov_b64 exec, s[66:67]
    s_cbranch_execz K2_SC5
    ds_write_b64 v105, v[66:67]
K2_SC5:
    s_mov_b64 exec, s[68:69]
    ds_write_b64 v106, v[68:69]
    s_mov_b64 exec, s[70:71]
    s_cbranch_execz K2_SC7
    ds_write_b64 v107, v[70:71]
K2_SC7:
    s_mov_b64 exec, -1
    s_waitcnt lgkmcnt(0)
    s_barrier
    s_cmp_lg_u32 s22, 15
    s_cbranch_scc1 K2_NONI
    s_add_u32 s3, s74, 1
    v_cvt_f32_u32 v44, s3
    v_cvt_f32_u32 v45, s74
    v_rcp_f32 v44, v44
    v_rcp_f32 v45, v45
    s_mul_i32 s3, s3, s75
    s_lshl_b32 s3, s3, 3
    v_cvt_f32_u32 v46, s3
    s_lshl_b32 s90, s75, 3
    v_add_u32 v100, -1, v97
    v_add_u32 v101, -1, v95
    v_cvt_f32_u32 v48, v96
    v_add_f32 v48, 0.5, v48
    v_sub_f32 v49, v48, v46
    v_mul_f32 v48, v48, v44
    v_mul_f32 v49, v49, v45
    v_cvt_u32_f32 v48, v48
    v_cvt_u32_f32 v49, v49
    v_cmp_gt_u32 vcc, s3, v96
    v_add_u32 v49, s90, v49
    s_nop 0
    v_cndmask_b32 v96, v49, v48, vcc
    v_cvt_f32_u32 v48, v97
    v_add_f32 v48, 0.5, v48
    v_sub_f32 v49, v48, v46
    v_mul_f32 v48, v48, v44
    v_mul_f32 v49, v49, v45
    v_cvt_u32_f32 v48, v48
    v_cvt_u32_f32 v49, v49
    v_cmp_gt_u32 vcc, s3, v97
    v_add_u32 v49, s90, v49
    s_nop 0
    v_cndmask_b32 v97, v49, v48, vcc
    v_cvt_f32_u32 v48, v100
    v_add_f32 v48, 0.5, v48
    v_sub_f32 v49, v48, v46
    v_mul_f32 v48, v48, v44
    v_mul_f32 v49, v49, v45
    v_cvt_u32_f32 v48, v48
    v_cvt_u32_f32 v49, v49
    v_cmp_gt_u32 vcc, s3, v100
    v_add_u32 v49, s90, v49
    s_nop 0
    v_cndmask_b32 v100, v49, v48, vcc
    v_cvt_f32_u32 v48, v101
    v_add_f32 v48, 0.5, v48
    v_sub_f32 v49, v48, v46
    v_mul_f32 v48, v48, v44
    v_mul_f32 v49, v49, v45
    v_cvt_u32_f32 v48, v48
    v_cvt_u32_f32 v49, v49
    v_cmp_gt_u32 vcc, s3, v101
    v_add_u32 v49, s90, v49
    s_nop 0
    v_cndmask_b32 v101, v49, v48, vcc
    v_sub_u32 v100, v100, v96
    v_add_u32 v100, 1, v100
    v_cmp_lt_u32 vcc, 0, v92
    v_lshlrev_b32 v92, 2, v92
    v_sub_u32 v92, v92, v88
    v_cndmask_b32 v100, 0, v100, vcc
    v_and_b32 v96, 0xff, v96
    v_lshl_or_b32 v96, v100, 8, v96
    v_lshl_or_b32 v96, v92, 16, v96
    v_sub_u32 v101, v101, v97
    v_add_u32 v101, 1, v101
    v_cmp_lt_u32 vcc, 0, v93
    v_lshlrev_b32 v93, 2, v93
    v_sub_u32 v93, v93, v89
    v_cndmask_b32 v101, 0, v101, vcc
    v_and_b32 v97, 0xff, v97
    v_lshl_or_b32 v97, v101, 8, v97
    v_lshl_or_b32 v97, v93, 16, v97
    ds_write_b64 v5, v[96:97] offset:1280
K2_NONI:
    s_cmp_eq_u32 s76, 0
    s_cbranch_scc1 K2_MAIN_DONE
    s_cmp_lg_u32 s84, 0
    s_cbranch_scc1 K2_MAIN_S
K2_MAIN_F:
    ds_read_b128 v[40:43], v4
    ds_read_b128 v[44:47], v4 offset:16
    ds_read_b128 v[48:51], v4 offset:32
    ds_read_b128 v[52:55], v4 offset:48
    v_mov_b64 v[16:17], 0
    v_mov_b64 v[18:19], 0
    v_mov_b64 v[20:21], 0
    v_mov_b64 v[22:23], 0
    s_sub_u32 s77, s76, 1
    s_setprio 3
    s_waitcnt lgkmcnt(2)
    v_and_or_b32 v36, v40, s79, v1
    buffer_load_dwordx4 v[56:59], v36, s[28:31], 0 offen sc1
    v_and_or_b32 v37, v42, s79, v1
    buffer_load_dwordx4 v[60:63], v37, s[28:31], 0 offen sc1
    v_and_or_b32 v38, v44, s79, v1
    buffer_load_dwordx4 v[64:67], v38, s[28:31], 0 offen sc1
    v_and_or_b32 v39, v46, s79, v1
    buffer_load_dwordx4 v[68:71], v39, s[28:31], 0 offen sc1
    v_lshrrev_b32 v5, 24, v40
    v_mad_u32_u24 v5, v5, s50, v2
    ds_read_b128 v[88:91], v5
    ds_read_b128 v[92:95], v5 offset:128
    s_waitcnt lgkmcnt(0)
K2_LOOP_FA:
    s_cmp_eq_u32 s77, 0
    s_cbranch_scc1 K2_LAST_FA
    s_cmp_gt_u32 s77, 2
    s_cbranch_scc1 K2_PR_FA
    s_setprio 2
    s_cmp_eq_u32 s77, 2
    s_cbranch_scc1 K2_PR_FA
    s_setprio 1
K2_PR_FA:
    s_waitcnt lgkmcnt(2)
    v_and_or_b32 v36, v48, s79, v1
    buffer_load_dwordx4 v[72:75], v36, s[28:31], 0 offen sc1
    v_and_or_b32 v37, v50, s79, v1
    buffer_load_dwordx4 v[76:79], v37, s[28:31], 0 offen sc1
    v_and_or_b32 v38, v52, s79, v1
    buffer_load_dwordx4 v[80:83], v38, s[28:31], 0 offen sc1
    v_and_or_b32 v39, v54, s79, v1
    buffer_load_dwordx4 v[84:87], v39, s[28:31], 0 offen sc1
    s_waitcnt vmcnt(4)
    s_branch K2_GO_FA
K2_LAST_FA:
    s_setprio 0
    s_waitcnt vmcnt(0) lgkmcnt(2)
K2_GO_FA:
    v_pk_fma_f32 v[96:97], v[40:41], v[8:9], v[88:89] op_sel:[1,0,0] op_sel_hi:[1,1,1]
    v_pk_fma_f32 v[98:99], v[40:41], v[10:11], v[90:91] op_sel:[1,0,0] op_sel_hi:[1,1,1]
    v_pk_fma_f32 v[100:101], v[40:41], v[12:13], v[92:93] op_sel:[1,0,0] op_sel_hi:[1,1,1]
    v_pk_fma_f32 v[102:103], v[40:41], v[14:15], v[94:95] op_sel:[1,0,0] op_sel_hi:[1,1,1]
    v_dot2_f32_bf16 v100, v56, s78, v100
    v_dot2_f32_bf16 v101, v57, s78, v101
    v_dot2_f32_bf16 v102, v58, s78, v102
    v_dot2_f32_bf16 v103, v59, s78, v103
    v_pk_add_f32 v[96:97], v[56:57], v[96:97]
    v_pk_add_f32 v[98:99], v[58:59], v[98:99]
    v_exp_f32 v120, v96
    v_exp_f32 v121, v97
    v_exp_f32 v122, v98
    v_exp_f32 v123, v99
    v_exp_f32 v124, v100
    v_exp_f32 v125, v101
    v_exp_f32 v126, v102
    v_exp_f32 v127, v103
    v_pk_add_f32 v[104:105], v[120:121], 1.0 op_sel_hi:[1,0]
    v_pk_add_f32 v[106:107], v[122:123], 1.0 op_sel_hi:[1,0]
    v_pk_add_f32 v[108:109], v[124:125], 1.0 op_sel_hi:[1,0]
    v_pk_add_f32 v[110:111], v[126:127], 1.0 op_sel_hi:[1,0]
    v_pk_fma_f32 v[112:113], v[42:43], v[8:9], v[88:89] op_sel:[1,0,0] op_sel_hi:[1,1,1]
    v_pk_fma_f32 v[114:115], v[42:43], v[10:11], v[90:91] op_sel:[1,0,0] op_sel_hi:[1,1,1]
    v_pk_fma_f32 v[116:117], v[42:43], v[12:13], v[92:93] op_sel:[1,0,0] op_sel_hi:[1,1,1]
    v_pk_fma_f32 v[118:119], v[42:43], v[14:15], v[94:95] op_sel:[1,0,0] op_sel_hi:[1,1,1]
    v_dot2_f32_bf16 v116, v60, s78, v116
    v_dot2_f32_bf16 v117, v61, s78, v117
    v_dot2_f32_bf16 v118, v62, s78, v118
    v_dot2_f32_bf16 v119, v63, s78, v119
    v_pk_add_f32 v[112:113], v[60:61], v[112:113]
    v_pk_add_f32 v[114:115], v[62:63], v[114:115]
    v_exp_f32 v120, v112
    v_exp_f32 v121, v113
    v_exp_f32 v122, v114
    v_exp_f32 v123, v115
    v_exp_f32 v124, v116
    v_exp_f32 v125, v117
    v_exp_f32 v126, v118
    v_exp_f32 v127, v119
    v_pk_fma_f32 v[96:97], v[96:97], v[120:121], v[96:97]
    v_pk_fma_f32 v[98:99], v[98:99], v[122:123], v[98:99]
    v_pk_fma_f32 v[100:101], v[100:101], v[124:125], v[100:101]
    v_pk_fma_f32 v[102:103], v[102:103], v[126:127], v[102:103]
    v_pk_fma_f32 v[96:97], v[112:113], v[104:105], v[96:97]
    v_pk_fma_f32 v[98:99], v[114:115], v[106:107], v[98:99]
    v_pk_fma_f32 v[100:101], v[116:117], v[108:109], v[100:101]
    v_pk_fma_f32 v[102:103], v[118:119], v[110:111], v[102:103]
    v_pk_fma_f32 v[104:105], v[104:105], v[120:121], v[104:105]
    v_pk_fma_f32 v[106:107], v[106:107], v[122:123], v[106:107]
    v_pk_fma_f32 v[108:109], v[108:109], v[124:125], v[108:109]
    v_pk_fma_f32 v[110:111], v[110:111], v[126:127], v[110:111]
    v_pk_fma_f32 v[112:113], v[44:45], v[8:9], v[88:89] op_sel:[1,0,0] op_sel_hi:[1,1,1]
    v_pk_fma_f32 v[114:115], v[44:45], v[10:11], v[90:91] op_sel:[1,0,0] op_sel_hi:[1,1,1]
    v_pk_fma_f32 v[116:117], v[44:45], v[12:13], v[92:93] op_sel:[1,0,0] op_sel_hi:[1,1,1]
    v_pk_fma_f32 v[118:119], v[44:45], v[14:15], v[94:95] op_sel:[1,0,0] op_sel_hi:[1,1,1]
    v_dot2_f32_bf16 v116, v64, s78, v116
    v_dot2_f32_bf16 v117, v65, s78, v117
    v_dot2_f32_bf16 v118, v66, s78, v118
    v_dot2_f32_bf16 v119, v67, s78, v119
    v_pk_add_f32 v[112:113], v[64:65], v[112:113]
    v_pk_add_f32 v[114:115], v[66:67], v[114:115]
    v_exp_f32 v120, v112
    v_exp_f32 v121, v113
    v_exp_f32 v122, v114
    v_exp_f32 v123, v115
    v_exp_f32 v124, v116
    v_exp_f32 v125, v117
    v_exp_f32 v126, v118
    v_exp_f32 v127, v119
    v_pk_fma_f32 v[96:97], v[96:97], v[120:121], v[96:97]
    v_pk_fma_f32 v[98:99], v[98:99], v[122:123], v[98:99]
    v_pk_fma_f32 v[100:101], v[100:101], v[124:125], v[100:101]
    v_pk_fma_f32 v[102:103], v[102:103], v[126:127], v[102:103]
    v_pk_fma_f32 v[96:97], v[112:113], v[104:105], v[96:97]
    v_pk_fma_f32 v[98:99], v[114:115], v[106:107], v[98:99]
    v_pk_fma_f32 v[100:101], v[116:117], v[108:109], v[100:101]
    v_pk_fma_f32 v[102:103], v[118:119], v[110:111], v[102:103]
    v_pk_fma_f32 v[104:105], v[104:105], v[120:121], v[104:105]
    v_pk_fma_f32 v[106:107], v[106:107], v[122:123], v[106:107]
    v_pk_fma_f32 v[108:109], v[108:109], v[124:125], v[108:109]
    v_pk_fma_f32 v[110:111], v[110:111], v[126:127], v[110:111]
    v_pk_fma_f32 v[112:113], v[46:47], v[8:9], v[88:89] op_sel:[1,0,0] op_sel_hi:[1,1,1]
    v_pk_fma_f32 v[114:115], v[46:47], v[10:11], v[90:91] op_sel:[1,0,0] op_sel_hi:[1,1,1]
    v_pk_fma_f32 v[116:117], v[46:47], v[12:13], v[92:93] op_sel:[1,0,0] op_sel_hi:[1,1,1]
    v_pk_fma_f32 v[118:119], v[46:47], v[14:15], v[94:95] op_sel:[1,0,0] op_sel_hi:[1,1,1]
    v_add_u32 v7, v5, v3
    v_lshrrev_b32 v6, 24, v48
    v_mad_u32_u24 v6, v6, s50, v2
    ds_read_b128 v[88:91], v6
    ds_read_b128 v[92:95], v6 offset:128
    ds_read_b128 v[40:43], v4 offset:64
    ds_read_b128 v[44:47], v4 offset:80
    v_dot2_f32_bf16 v116, v68, s78, v116
    v_dot2_f32_bf16 v117, v69, s78, v117
    v_dot2_f32_bf16 v118, v70, s78, v118
    v_dot2_f32_bf16 v119, v71, s78, v119
    v_pk_add_f32 v[112:113], v[68:69], v[112:113]
    v_pk_add_f32 v[114:115], v[70:71], v[114:115]
    v_exp_f32 v120, v112
    v_exp_f32 v121, v113
    v_exp_f32 v122, v114
    v_exp_f32 v123, v115
    v_exp_f32 v124, v116
    v_exp_f32 v125, v117
    v_exp_f32 v126, v118
    v_exp_f32 v127, v119
    v_pk_fma_f32 v[96:97], v[96:97], v[120:121], v[96:97]
    v_pk_fma_f32 v[98:99], v[98:99], v[122:123], v[98:99]
    v_pk_fma_f32 v[100:101], v[100:101], v[124:125], v[100:101]
    v_pk_fma_f32 v[102:103], v[102:103], v[126:127], v[102:103]
    v_pk_fma_f32 v[96:97], v[112:113], v[104:105], v[96:97]
    v_pk_fma_f32 v[98:99], v[114:115], v[106:107], v[98:99]
    v_pk_fma_f32 v[100:101], v[116:117], v[108:109], v[100:101]
    v_pk_fma_f32 v[102:103], v[118:119], v[110:111], v[102:103]
    v_pk_fma_f32 v[104:105], v[104:105], v[120:121], v[104:105]
    v_pk_fma_f32 v[106:107], v[106:107], v[122:123], v[106:107]
    v_pk_fma_f32 v[108:109], v[108:109], v[124:125], v[108:109]
    v_pk_fma_f32 v[110:111], v[110:111], v[126:127], v[110:111]
    v_rcp_f32 v120, v104
    v_rcp_f32 v121, v105
    v_rcp_f32 v122, v106
    v_rcp_f32 v123, v107
    v_rcp_f32 v124, v108
    v_rcp_f32 v125, v109
    v_rcp_f32 v126, v110
    v_rcp_f32 v127, v111
    s_nop 0
    v_pk_fma_f32 v[16:17], v[96:97], v[120:121], v[16:17]
    v_pk_fma_f32 v[18:19], v[98:99], v[122:123], v[18:19]
    v_pk_fma_f32 v[20:21], v[100:101], v[124:125], v[20:21]
    v_pk_fma_f32 v[22:23], v[102:103], v[126:127], v[22:23]
    ds_write_b128 v7, v[16:19]
    ds_write_b128 v7, v[20:23] offset:128
    s_cmp_eq_u32 s77, 0
    s_cbranch_scc1 K2_MAIN_DONE
    s_sub_u32 s77, s77, 1
    v_cmp_ne_u32 vcc, v6, v5
    s_and_saveexec_b64 s[80:81], vcc
    s_cbranch_execz K2_KEEP_FA
    v_mov_b64 v[16:17], 0
    v_mov_b64 v[18:19], 0
    v_mov_b64 v[20:21], 0
    v_mov_b64 v[22:23], 0
K2_KEEP_FA:
    s_mov_b64 exec, -1
K2_LOOP_FB:
    s_cmp_eq_u32 s77, 0
    s_cbranch_scc1 K2_LAST_FB
    s_cmp_gt_u32 s77, 2
    s_cbranch_scc1 K2_PR_FB
    s_setprio 2
    s_cmp_eq_u32 s77, 2
    s_cbranch_scc1 K2_PR_FB
    s_setprio 1
K2_PR_FB:
    s_waitcnt lgkmcnt(2)
    v_and_or_b32 v36, v40, s79, v1
    buffer_load_dwordx4 v[56:59], v36, s[28:31], 0 offen sc1
    v_and_or_b32 v37, v42, s79, v1
    buffer_load_dwordx4 v[60:63], v37, s[28:31], 0 offen sc1
    v_and_or_b32 v38, v44, s79, v1
    buffer_load_dwordx4 v[64:67], v38, s[28:31], 0 offen sc1
    v_and_or_b32 v39, v46, s79, v1
    buffer_load_dwordx4 v[68:71], v39, s[28:31], 0 offen sc1
    s_waitcnt vmcnt(4)
    s_branch K2_GO_FB
K2_LAST_FB:
    s_setprio 0
    s_waitcnt vmcnt(0) lgkmcnt(2)
K2_GO_FB:
    v_pk_fma_f32 v[96:97], v[48:49], v[8:9], v[88:89] op_sel:[1,0,0] op_sel_hi:[1,1,1]
    v_pk_fma_f32 v[98:99], v[48:49], v[10:11], v[90:91] op_sel:[1,0,0] op_sel_hi:[1,1,1]
    v_pk_fma_f32 v[100:101], v[48:49], v[12:13], v[92:93] op_sel:[1,0,0] op_sel_hi:[1,1,1]
    v_pk_fma_f32 v[102:103], v[48:49], v[14:15], v[94:95] op_sel:[1,0,0] op_sel_hi:[1,1,1]
    v_dot2_f32_bf16 v100, v72, s78, v100
    v_dot2_f32_bf16 v101, v73, s78, v101
    v_dot2_f32_bf16 v102, v74, s78, v102
    v_dot2_f32_bf16 v103, v75, s78, v103
    v_pk_add_f32 v[96:97], v[72:73], v[96:97]
    v_pk_add_f32 v[98:99], v[74:75], v[98:99]
    v_exp_f32 v120, v96
    v_exp_f32 v121, v97
    v_exp_f32 v122, v98
    v_exp_f32 v123, v99
    v_exp_f32 v124, v100
    v_exp_f32 v125, v101
    v_exp_f32 v126, v102
    v_exp_f32 v127, v103
    v_pk_add_f32 v[104:105], v[120:121], 1.0 op_sel_hi:[1,0]
    v_pk_add_f32 v[106:107], v[122:123], 1.0 op_sel_hi:[1,0]
    v_pk_add_f32 v[108:109], v[124:125], 1.0 op_sel_hi:[1,0]
    v_pk_add_f32 v[110:111], v[126:127], 1.0 op_sel_hi:[1,0]
    v_pk_fma_f32 v[112:113], v[50:51], v[8:9], v[88:89] op_sel:[1,0,0] op_sel_hi:[1,1,1]
    v_pk_fma_f32 v[114:115], v[50:51], v[10:11], v[90:91] op_sel:[1,0,0] op_sel_hi:[1,1,1]
    v_pk_fma_f32 v[116:117], v[50:51], v[12:13], v[92:93] op_sel:[1,0,0] op_sel_hi:[1,1,1]
    v_pk_fma_f32 v[118:119], v[50:51], v[14:15], v[94:95] op_sel:[1,0,0] op_sel_hi:[1,1,1]
    v_dot2_f32_bf16 v116, v76, s78, v116
    v_dot2_f32_bf16 v117, v77, s78, v117
    v_dot2_f32_bf16 v118, v78, s78, v118
    v_dot2_f32_bf16 v119, v79, s78, v119
    v_pk_add_f32 v[112:113], v[76:77], v[112:113]
    v_pk_add_f32 v[114:115], v[78:79], v[114:115]
    v_exp_f32 v120, v112
    v_exp_f32 v121, v113
    v_exp_f32 v122, v114
    v_exp_f32 v123, v115
    v_exp_f32 v124, v116
    v_exp_f32 v125, v117
    v_exp_f32 v126, v118
    v_exp_f32 v127, v119
    v_pk_fma_f32 v[96:97], v[96:97], v[120:121], v[96:97]
    v_pk_fma_f32 v[98:99], v[98:99], v[122:123], v[98:99]
    v_pk_fma_f32 v[100:101], v[100:101], v[124:125], v[100:101]
    v_pk_fma_f32 v[102:103], v[102:103], v[126:127], v[102:103]
    v_pk_fma_f32 v[96:97], v[112:113], v[104:105], v[96:97]
    v_pk_fma_f32 v[98:99], v[114:115], v[106:107], v[98:99]
    v_pk_fma_f32 v[100:101], v[116:117], v[108:109], v[100:101]
    v_pk_fma_f32 v[102:103], v[118:119], v[110:111], v[102:103]
    v_pk_fma_f32 v[104:105], v[104:105], v[120:121], v[104:105]
    v_pk_fma_f32 v[106:107], v[106:107], v[122:123], v[106:107]
    v_pk_fma_f32 v[108:109], v[108:109], v[124:125], v[108:109]
    v_pk_fma_f32 v[110:111], v[110:111], v[126:127], v[110:111]
    v_pk_fma_f32 v[112:113], v[52:53], v[8:9], v[88:89] op_sel:[1,0,0] op_sel_hi:[1,1,1]
    v_pk_fma_f32 v[114:115], v[52:53], v[10:11], v[90:91] op_sel:[1,0,0] op_sel_hi:[1,1,1]
    v_pk_fma_f32 v[116:117], v[52:53], v[12:13], v[92:93] op_sel:[1,0,0] op_sel_hi:[1,1,1]
    v_pk_fma_f32 v[118:119], v[52:53], v[14:15], v[94:95] op_sel:[1,0,0] op_sel_hi:[1,1,1]
    v_dot2_f32_bf16 v116, v80, s78, v116
    v_dot2_f32_bf16 v117, v81, s78, v117
    v_dot2_f32_bf16 v118, v82, s78, v118
    v_dot2_f32_bf16 v119, v83, s78, v119
    v_pk_add_f32 v[112:113], v[80:81], v[112:113]
    v_pk_add_f32 v[114:115], v[82:83], v[114:115]
    v_exp_f32 v120, v112
    v_exp_f32 v121, v113
    v_exp_f32 v122, v114
    v_exp_f32 v123, v115
    v_exp_f32 v124, v116
    v_exp_f32 v125, v117
    v_exp_f32 v126, v118
    v_exp_f32 v127, v119
    v_pk_fma_f32 v[96:97], v[96:97], v[120:121], v[96:97]
    v_pk_fma_f32 v[98:99], v[98:99], v[122:123], v[98:99]
    v_pk_fma_f32 v[100:101], v[100:101], v[124:125], v[100:101]
    v_pk_fma_f32 v[102:103], v[102:103], v[126:127], v[102:103]
    v_pk_fma_f32 v[96:97], v[112:113], v[104:105], v[96:97]
    v_pk_fma_f32 v[98:99], v[114:115], v[106:107], v[98:99]
    v_pk_fma_f32 v[100:101], v[116:117], v[108:109], v[100:101]
    v_pk_fma_f32 v[102:103], v[118:119], v[110:111], v[102:103]
    v_pk_fma_f32 v[104:105], v[104:105], v[120:121], v[104:105]
    v_pk_fma_f32 v[106:107], v[106:107], v[122:123], v[106:107]
    v_pk_fma_f32 v[108:109], v[108:109], v[124:125], v[108:109]
    v_pk_fma_f32 v[110:111], v[110:111], v[126:127], v[110:111]
    v_pk_fma_f32 v[112:113], v[54:55], v[8:9], v[88:89] op_sel:[1,0,0] op_sel_hi:[1,1,1]
    v_pk_fma_f32 v[114:115], v[54:55], v[10:11], v[90:91] op_sel:[1,0,0] op_sel_hi:[1,1,1]
    v_pk_fma_f32 v[116:117], v[54:55], v[12:13], v[92:93] op_sel:[1,0,0] op_sel_hi:[1,1,1]
    v_pk_fma_f32 v[118:119], v[54:55], v[14:15], v[94:95] op_sel:[1,0,0] op_sel_hi:[1,1,1]
    v_add_u32 v7, v6, v3
    v_lshrrev_b32 v5, 24, v40
    v_mad_u32_u24 v5, v5, s50, v2
    ds_read_b128 v[88:91], v5
    ds_read_b128 v[92:95], v5 offset:128
    ds_read_b128 v[48:51], v4 offset:96
    ds_read_b128 v[52:55], v4 offset:112
    v_add_u32 v4, 64, v4
    v_dot2_f32_bf16 v116, v84, s78, v116
    v_dot2_f32_bf16 v117, v85, s78, v117
    v_dot2_f32_bf16 v118, v86, s78, v118
    v_dot2_f32_bf16 v119, v87, s78, v119
    v_pk_add_f32 v[112:113], v[84:85], v[112:113]
    v_pk_add_f32 v[114:115], v[86:87], v[114:115]
    v_exp_f32 v120, v112
    v_exp_f32 v121, v113
    v_exp_f32 v122, v114
    v_exp_f32 v123, v115
    v_exp_f32 v124, v116
    v_exp_f32 v125, v117
    v_exp_f32 v126, v118
    v_exp_f32 v127, v119
    v_pk_fma_f32 v[96:97], v[96:97], v[120:121], v[96:97]
    v_pk_fma_f32 v[98:99], v[98:99], v[122:123], v[98:99]
    v_pk_fma_f32 v[100:101], v[100:101], v[124:125], v[100:101]
    v_pk_fma_f32 v[102:103], v[102:103], v[126:127], v[102:103]
    v_pk_fma_f32 v[96:97], v[112:113], v[104:105], v[96:97]
    v_pk_fma_f32 v[98:99], v[114:115], v[106:107], v[98:99]
    v_pk_fma_f32 v[100:101], v[116:117], v[108:109], v[100:101]
    v_pk_fma_f32 v[102:103], v[118:119], v[110:111], v[102:103]
    v_pk_fma_f32 v[104:105], v[104:105], v[120:121], v[104:105]
    v_pk_fma_f32 v[106:107], v[106:107], v[122:123], v[106:107]
    v_pk_fma_f32 v[108:109], v[108:109], v[124:125], v[108:109]
    v_pk_fma_f32 v[110:111], v[110:111], v[126:127], v[110:111]
    v_rcp_f32 v120, v104
    v_rcp_f32 v121, v105
    v_rcp_f32 v122, v106
    v_rcp_f32 v123, v107
    v_rcp_f32 v124, v108
    v_rcp_f32 v125, v109
    v_rcp_f32 v126, v110
    v_rcp_f32 v127, v111
    s_nop 0
    v_pk_fma_f32 v[16:17], v[96:97], v[120:121], v[16:17]
    v_pk_fma_f32 v[18:19], v[98:99], v[122:123], v[18:19]
    v_pk_fma_f32 v[20:21], v[100:101], v[124:125], v[20:21]
    v_pk_fma_f32 v[22:23], v[102:103], v[126:127], v[22:23]
    ds_write_b128 v7, v[16:19]
    ds_write_b128 v7, v[20:23] offset:128
    s_cmp_eq_u32 s77, 0
    s_cbranch_scc1 K2_MAIN_DONE
    s_sub_u32 s77, s77, 1
    v_cmp_ne_u32 vcc, v6, v5
    s_and_saveexec_b64 s[80:81], vcc
    s_cbranch_execz K2_KEEP_FB
    v_mov_b64 v[16:17], 0
    v_mov_b64 v[18:19], 0
    v_mov_b64 v[20:21], 0
    v_mov_b64 v[22:23], 0
K2_KEEP_FB:
    s_mov_b64 exec, -1
    s_branch K2_LOOP_FA
K2_MAIN_S:
    ds_read_b128 v[40:43], v4
    ds_read_b128 v[44:47], v4 offset:16
    ds_read_b128 v[48:51], v4 offset:32
    ds_read_b128 v[52:55], v4 offset:48
    v_mov_b64 v[16:17], 0
    v_mov_b64 v[18:19], 0
    v_mov_b64 v[20:21], 0
    v_mov_b64 v[22:23], 0
    s_sub_u32 s77, s76, 1
    s_setprio 3
    s_waitcnt lgkmcnt(2)
    v_and_or_b32 v36, v40, s79, v1
    buffer_load_dwordx4 v[56:59], v36, s[28:31], 0 offen sc1
    v_and_or_b32 v37, v42, s79, v1
    buffer_load_dwordx4 v[60:63], v37, s[28:31], 0 offen sc1
    v_and_or_b32 v38, v44, s79, v1
    buffer_load_dwordx4 v[64:67], v38, s[28:31], 0 offen sc1
    v_and_or_b32 v39, v46, s79, v1
    buffer_load_dwordx4 v[68:71], v39, s[28:31], 0 offen sc1
    v_lshrrev_b32 v5, 24, v40
    v_mad_u32_u24 v5, v5, s50, v2
    ds_read_b128 v[88:91], v5
    ds_read_b128 v[92:95], v5 offset:128
    s_waitcnt lgkmcnt(0)
K2_LOOP_SA:
    s_cmp_eq_u32 s77, 0
    s_cbranch_scc1 K2_LAST_SA
    s_cmp_gt_u32 s77, 2
    s_cbranch_scc1 K2_PR_SA
    s_setprio 2
    s_cmp_eq_u32 s77, 2
    s_cbranch_scc1 K2_PR_SA
    s_setprio 1
K2_PR_SA:
    s_waitcnt lgkmcnt(2)
    v_and_or_b32 v36, v48, s79, v1
    buffer_load_dwordx4 v[72:75], v36, s[28:31], 0 offen sc1
    v_and_or_b32 v37, v50, s79, v1
    buffer_load_dwordx4 v[76:79], v37, s[28:31], 0 offen sc1
    v_and_or_b32 v38, v52, s79, v1
    buffer_load_dwordx4 v[80:83], v38, s[28:31], 0 offen sc1
    v_and_or_b32 v39, v54, s79, v1
    buffer_load_dwordx4 v[84:87], v39, s[28:31], 0 offen sc1
    s_waitcnt vmcnt(4)
    s_branch K2_GO_SA
K2_LAST_SA:
    s_setprio 0
    s_waitcnt vmcnt(0) lgkmcnt(2)
K2_GO_SA:
    v_pk_fma_f32 v[112:113], v[40:41], v[8:9], v[88:89] op_sel:[1,0,0] op_sel_hi:[1,1,1]
    v_pk_fma_f32 v[114:115], v[40:41], v[10:11], v[90:91] op_sel:[1,0,0] op_sel_hi:[1,1,1]
    v_pk_fma_f32 v[116:117], v[40:41], v[12:13], v[92:93] op_sel:[1,0,0] op_sel_hi:[1,1,1]
    v_pk_fma_f32 v[118:119], v[40:41], v[14:15], v[94:95] op_sel:[1,0,0] op_sel_hi:[1,1,1]
    v_dot2_f32_bf16 v116, v56, s78, v116
    v_dot2_f32_bf16 v117, v57, s78, v117
    v_dot2_f32_bf16 v118, v58, s78, v118
    v_dot2_f32_bf16 v119, v59, s78, v119
    v_pk_add_f32 v[112:113], v[56:57], v[112:113]
    v_pk_add_f32 v[114:115], v[58:59], v[114:115]
    v_exp_f32 v120, v112
    v_exp_f32 v121, v113
    v_exp_f32 v122, v114
    v_exp_f32 v123, v115
    v_exp_f32 v124, v116
    v_exp_f32 v125, v117
    v_exp_f32 v126, v118
    v_exp_f32 v127, v119
    v_pk_add_f32 v[120:121], v[120:121], 1.0 op_sel_hi:[1,0]
    v_pk_add_f32 v[122:123], v[122:123], 1.0 op_sel_hi:[1,0]
    v_pk_add_f32 v[124:125], v[124:125], 1.0 op_sel_hi:[1,0]
    v_pk_add_f32 v[126:127], v[126:127], 1.0 op_sel_hi:[1,0]
    v_rcp_f32 v120, v120
    v_rcp_f32 v121, v121
    v_rcp_f32 v122, v122
    v_rcp_f32 v123, v123
    v_rcp_f32 v124, v124
    v_rcp_f32 v125, v125
    v_rcp_f32 v126, v126
    v_rcp_f32 v127, v127
    s_nop 0
    v_pk_fma_f32 v[16:17], v[112:113], v[120:121], v[16:17]
    v_pk_fma_f32 v[18:19], v[114:115], v[122:123], v[18:19]
    v_pk_fma_f32 v[20:21], v[116:117], v[124:125], v[20:21]
    v_pk_fma_f32 v[22:23], v[118:119], v[126:127], v[22:23]
    v_pk_fma_f32 v[112:113], v[42:43], v[8:9], v[88:89] op_sel:[1,0,0] op_sel_hi:[1,1,1]
    v_pk_fma_f32 v[114:115], v[42:43], v[10:11], v[90:91] op_sel:[1,0,0] op_sel_hi:[1,1,1]
    v_pk_fma_f32 v[116:117], v[42:43], v[12:13], v[92:93] op_sel:[1,0,0] op_sel_hi:[1,1,1]
    v_pk_fma_f32 v[118:119], v[42:43], v[14:15], v[94:95] op_sel:[1,0,0] op_sel_hi:[1,1,1]
    v_dot2_f32_bf16 v116, v60, s78, v116
    v_dot2_f32_bf16 v117, v61, s78, v117
    v_dot2_f32_bf16 v118, v62, s78, v118
    v_dot2_f32_bf16 v119, v63, s78, v119
    v_pk_add_f32 v[112:113], v[60:61], v[112:113]
    v_pk_add_f32 v[114:115], v[62:63], v[114:115]
    v_exp_f32 v120, v112
    v_exp_f32 v121, v113
    v_exp_f32 v122, v114
    v_exp_f32 v123, v115
    v_exp_f32 v124, v116
    v_exp_f32 v125, v117
    v_exp_f32 v126, v118
    v_exp_f32 v127, v119
    v_pk_add_f32 v[120:121], v[120:121], 1.0 op_sel_hi:[1,0]
    v_pk_add_f32 v[122:123], v[122:123], 1.0 op_sel_hi:[1,0]
    v_pk_add_f32 v[124:125], v[124:125], 1.0 op_sel_hi:[1,0]
    v_pk_add_f32 v[126:127], v[126:127], 1.0 op_sel_hi:[1,0]
    v_rcp_f32 v120, v120
    v_rcp_f32 v121, v121
    v_rcp_f32 v122, v122
    v_rcp_f32 v123, v123
    v_rcp_f32 v124, v124
    v_rcp_f32 v125, v125
    v_rcp_f32 v126, v126
    v_rcp_f32 v127, v127
    s_nop 0
    v_pk_fma_f32 v[16:17], v[112:113], v[120:121], v[16:17]
    v_pk_fma_f32 v[18:19], v[114:115], v[122:123], v[18:19]
    v_pk_fma_f32 v[20:21], v[116:117], v[124:125], v[20:21]
    v_pk_fma_f32 v[22:23], v[118:119], v[126:127], v[22:23]
    v_pk_fma_f32 v[112:113], v[44:45], v[8:9], v[88:89] op_sel:[1,0,0] op_sel_hi:[1,1,1]
    v_pk_fma_f32 v[114:115], v[44:45], v[10:11], v[90:91] op_sel:[1,0,0] op_sel_hi:[1,1,1]
    v_pk_fma_f32 v[116:117], v[44:45], v[12:13], v[92:93] op_sel:[1,0,0] op_sel_hi:[1,1,1]
    v_pk_fma_f32 v[118:119], v[44:45], v[14:15], v[94:95] op_sel:[1,0,0] op_sel_hi:[1,1,1]
    v_dot2_f32_bf16 v116, v64, s78, v116
    v_dot2_f32_bf16 v117, v65, s78, v117
    v_dot2_f32_bf16 v118, v66, s78, v118
    v_dot2_f32_bf16 v119, v67, s78, v119
    v_pk_add_f32 v[112:113], v[64:65], v[112:113]
    v_pk_add_f32 v[114:115], v[66:67], v[114:115]
    v_exp_f32 v120, v112
    v_exp_f32 v121, v113
    v_exp_f32 v122, v114
    v_exp_f32 v123, v115
    v_exp_f32 v124, v116
    v_exp_f32 v125, v117
    v_exp_f32 v126, v118
    v_exp_f32 v127, v119
    v_pk_add_f32 v[120:121], v[120:121], 1.0 op_sel_hi:[1,0]
    v_pk_add_f32 v[122:123], v[122:123], 1.0 op_sel_hi:[1,0]
    v_pk_add_f32 v[124:125], v[124:125], 1.0 op_sel_hi:[1,0]
    v_pk_add_f32 v[126:127], v[126:127], 1.0 op_sel_hi:[1,0]
    v_rcp_f32 v120, v120
    v_rcp_f32 v121, v121
    v_rcp_f32 v122, v122
    v_rcp_f32 v123, v123
    v_rcp_f32 v124, v124
    v_rcp_f32 v125, v125
    v_rcp_f32 v126, v126
    v_rcp_f32 v127, v127
    s_nop 0
    v_pk_fma_f32 v[16:17], v[112:113], v[120:121], v[16:17]
    v_pk_fma_f32 v[18:19], v[114:115], v[122:123], v[18:19]
    v_pk_fma_f32 v[20:21], v[116:117], v[124:125], v[20:21]
    v_pk_fma_f32 v[22:23], v[118:119], v[126:127], v[22:23]
    v_pk_fma_f32 v[112:113], v[46:47], v[8:9], v[88:89] op_sel:[1,0,0] op_sel_hi:[1,1,1]
    v_pk_fma_f32 v[114:115], v[46:47], v[10:11], v[90:91] op_sel:[1,0,0] op_sel_hi:[1,1,1]
    v_pk_fma_f32 v[116:117], v[46:47], v[12:13], v[92:93] op_sel:[1,0,0] op_sel_hi:[1,1,1]
    v_pk_fma_f32 v[118:119], v[46:47], v[14:15], v[94:95] op_sel:[1,0,0] op_sel_hi:[1,1,1]
    v_add_u32 v7, v5, v3
    v_lshrrev_b32 v6, 24, v48
    v_mad_u32_u24 v6, v6, s50, v2
    ds_read_b128 v[88:91], v6
    ds_read_b128 v[92:95], v6 offset:128
    ds_read_b128 v[40:43], v4 offset:64
    ds_read_b128 v[44:47], v4 offset:80
    v_dot2_f32_bf16 v116, v68, s78, v116
    v_dot2_f32_bf16 v117, v69, s78, v117
    v_dot2_f32_bf16 v118, v70, s78, v118
    v_dot2_f32_bf16 v119, v71, s78, v119
    v_pk_add_f32 v[112:113], v[68:69], v[112:113]
    v_pk_add_f32 v[114:115], v[70:71], v[114:115]
    v_exp_f32 v120, v112
    v_exp_f32 v121, v113
    v_exp_f32 v122, v114
    v_exp_f32 v123, v115
    v_exp_f32 v124, v116
    v_exp_f32 v125, v117
    v_exp_f32 v126, v118
    v_exp_f32 v127, v119
    v_pk_add_f32 v[120:121], v[120:121], 1.0 op_sel_hi:[1,0]
    v_pk_add_f32 v[122:123], v[122:123], 1.0 op_sel_hi:[1,0]
    v_pk_add_f32 v[124:125], v[124:125], 1.0 op_sel_hi:[1,0]
    v_pk_add_f32 v[126:127], v[126:127], 1.0 op_sel_hi:[1,0]
    v_rcp_f32 v120, v120
    v_rcp_f32 v121, v121
    v_rcp_f32 v122, v122
    v_rcp_f32 v123, v123
    v_rcp_f32 v124, v124
    v_rcp_f32 v125, v125
    v_rcp_f32 v126, v126
    v_rcp_f32 v127, v127
    s_nop 0
    v_pk_fma_f32 v[16:17], v[112:113], v[120:121], v[16:17]
    v_pk_fma_f32 v[18:19], v[114:115], v[122:123], v[18:19]
    v_pk_fma_f32 v[20:21], v[116:117], v[124:125], v[20:21]
    v_pk_fma_f32 v[22:23], v[118:119], v[126:127], v[22:23]
    ds_write_b128 v7, v[16:19]
    ds_write_b128 v7, v[20:23] offset:128
    s_cmp_eq_u32 s77, 0
    s_cbranch_scc1 K2_MAIN_DONE
    s_sub_u32 s77, s77, 1
    v_cmp_ne_u32 vcc, v6, v5
    s_and_saveexec_b64 s[80:81], vcc
    s_cbranch_execz K2_KEEP_SA
    v_mov_b64 v[16:17], 0
    v_mov_b64 v[18:19], 0
    v_mov_b64 v[20:21], 0
    v_mov_b64 v[22:23], 0
K2_KEEP_SA:
    s_mov_b64 exec, -1
K2_LOOP_SB:
    s_cmp_eq_u32 s77, 0
    s_cbranch_scc1 K2_LAST_SB
    s_cmp_gt_u32 s77, 2
    s_cbranch_scc1 K2_PR_SB
    s_setprio 2
    s_cmp_eq_u32 s77, 2
    s_cbranch_scc1 K2_PR_SB
    s_setprio 1
K2_PR_SB:
    s_waitcnt lgkmcnt(2)
    v_and_or_b32 v36, v40, s79, v1
    buffer_load_dwordx4 v[56:59], v36, s[28:31], 0 offen sc1
    v_and_or_b32 v37, v42, s79, v1
    buffer_load_dwordx4 v[60:63], v37, s[28:31], 0 offen sc1
    v_and_or_b32 v38, v44, s79, v1
    buffer_load_dwordx4 v[64:67], v38, s[28:31], 0 offen sc1
    v_and_or_b32 v39, v46, s79, v1
    buffer_load_dwordx4 v[68:71], v39, s[28:31], 0 offen sc1
    s_waitcnt vmcnt(4)
    s_branch K2_GO_SB
K2_LAST_SB:
    s_setprio 0
    s_waitcnt vmcnt(0) lgkmcnt(2)
K2_GO_SB:
    v_pk_fma_f32 v[112:113], v[48:49], v[8:9], v[88:89] op_sel:[1,0,0] op_sel_hi:[1,1,1]
    v_pk_fma_f32 v[114:115], v[48:49], v[10:11], v[90:91] op_sel:[1,0,0] op_sel_hi:[1,1,1]
    v_pk_fma_f32 v[116:117], v[48:49], v[12:13], v[92:93] op_sel:[1,0,0] op_sel_hi:[1,1,1]
    v_pk_fma_f32 v[118:119], v[48:49], v[14:15], v[94:95] op_sel:[1,0,0] op_sel_hi:[1,1,1]
    v_dot2_f32_bf16 v116, v72, s78, v116
    v_dot2_f32_bf16 v117, v73, s78, v117
    v_dot2_f32_bf16 v118, v74, s78, v118
    v_dot2_f32_bf16 v119, v75, s78, v119
    v_pk_add_f32 v[112:113], v[72:73], v[112:113]
    v_pk_add_f32 v[114:115], v[74:75], v[114:115]
    v_exp_f32 v120, v112
    v_exp_f32 v121, v113
    v_exp_f32 v122, v114
    v_exp_f32 v123, v115
    v_exp_f32 v124, v116
    v_exp_f32 v125, v117
    v_exp_f32 v126, v118
    v_exp_f32 v127, v119
    v_pk_add_f32 v[120:121], v[120:121], 1.0 op_sel_hi:[1,0]
    v_pk_add_f32 v[122:123], v[122:123], 1.0 op_sel_hi:[1,0]
    v_pk_add_f32 v[124:125], v[124:125], 1.0 op_sel_hi:[1,0]
    v_pk_add_f32 v[126:127], v[126:127], 1.0 op_sel_hi:[1,0]
    v_rcp_f32 v120, v120
    v_rcp_f32 v121, v121
    v_rcp_f32 v122, v122
    v_rcp_f32 v123, v123
    v_rcp_f32 v124, v124
    v_rcp_f32 v125, v125
    v_rcp_f32 v126, v126
    v_rcp_f32 v127, v127
    s_nop 0
    v_pk_fma_f32 v[16:17], v[112:113], v[120:121], v[16:17]
    v_pk_fma_f32 v[18:19], v[114:115], v[122:123], v[18:19]
    v_pk_fma_f32 v[20:21], v[116:117], v[124:125], v[20:21]
    v_pk_fma_f32 v[22:23], v[118:119], v[126:127], v[22:23]
    v_pk_fma_f32 v[112:113], v[50:51], v[8:9], v[88:89] op_sel:[1,0,0] op_sel_hi:[1,1,1]
    v_pk_fma_f32 v[114:115], v[50:51], v[10:11], v[90:91] op_sel:[1,0,0] op_sel_hi:[1,1,1]
    v_pk_fma_f32 v[116:117], v[50:51], v[12:13], v[92:93] op_sel:[1,0,0] op_sel_hi:[1,1,1]
    v_pk_fma_f32 v[118:119], v[50:51], v[14:15], v[94:95] op_sel:[1,0,0] op_sel_hi:[1,1,1]
    v_dot2_f32_bf16 v116, v76, s78, v116
    v_dot2_f32_bf16 v117, v77, s78, v117
    v_dot2_f32_bf16 v118, v78, s78, v118
    v_dot2_f32_bf16 v119, v79, s78, v119
    v_pk_add_f32 v[112:113], v[76:77], v[112:113]
    v_pk_add_f32 v[114:115], v[78:79], v[114:115]
    v_exp_f32 v120, v112
    v_exp_f32 v121, v113
    v_exp_f32 v122, v114
    v_exp_f32 v123, v115
    v_exp_f32 v124, v116
    v_exp_f32 v125, v117
    v_exp_f32 v126, v118
    v_exp_f32 v127, v119
    v_pk_add_f32 v[120:121], v[120:121], 1.0 op_sel_hi:[1,0]
    v_pk_add_f32 v[122:123], v[122:123], 1.0 op_sel_hi:[1,0]
    v_pk_add_f32 v[124:125], v[124:125], 1.0 op_sel_hi:[1,0]
    v_pk_add_f32 v[126:127], v[126:127], 1.0 op_sel_hi:[1,0]
    v_rcp_f32 v120, v120
    v_rcp_f32 v121, v121
    v_rcp_f32 v122, v122
    v_rcp_f32 v123, v123
    v_rcp_f32 v124, v124
    v_rcp_f32 v125, v125
    v_rcp_f32 v126, v126
    v_rcp_f32 v127, v127
    s_nop 0
    v_pk_fma_f32 v[16:17], v[112:113], v[120:121], v[16:17]
    v_pk_fma_f32 v[18:19], v[114:115], v[122:123], v[18:19]
    v_pk_fma_f32 v[20:21], v[116:117], v[124:125], v[20:21]
    v_pk_fma_f32 v[22:23], v[118:119], v[126:127], v[22:23]
    v_pk_fma_f32 v[112:113], v[52:53], v[8:9], v[88:89] op_sel:[1,0,0] op_sel_hi:[1,1,1]
    v_pk_fma_f32 v[114:115], v[52:53], v[10:11], v[90:91] op_sel:[1,0,0] op_sel_hi:[1,1,1]
    v_pk_fma_f32 v[116:117], v[52:53], v[12:13], v[92:93] op_sel:[1,0,0] op_sel_hi:[1,1,1]
    v_pk_fma_f32 v[118:119], v[52:53], v[14:15], v[94:95] op_sel:[1,0,0] op_sel_hi:[1,1,1]
    v_dot2_f32_bf16 v116, v80, s78, v116
    v_dot2_f32_bf16 v117, v81, s78, v117
    v_dot2_f32_bf16 v118, v82, s78, v118
    v_dot2_f32_bf16 v119, v83, s78, v119
    v_pk_add_f32 v[112:113], v[80:81], v[112:113]
    v_pk_add_f32 v[114:115], v[82:83], v[114:115]
    v_exp_f32 v120, v112
    v_exp_f32 v121, v113
    v_exp_f32 v122, v114
    v_exp_f32 v123, v115
    v_exp_f32 v124, v116
    v_exp_f32 v125, v117
    v_exp_f32 v126, v118
    v_exp_f32 v127, v119
    v_pk_add_f32 v[120:121], v[120:121], 1.0 op_sel_hi:[1,0]
    v_pk_add_f32 v[122:123], v[122:123], 1.0 op_sel_hi:[1,0]
    v_pk_add_f32 v[124:125], v[124:125], 1.0 op_sel_hi:[1,0]
    v_pk_add_f32 v[126:127], v[126:127], 1.0 op_sel_hi:[1,0]
    v_rcp_f32 v120, v120
    v_rcp_f32 v121, v121
    v_rcp_f32 v122, v122
    v_rcp_f32 v123, v123
    v_rcp_f32 v124, v124
    v_rcp_f32 v125, v125
    v_rcp_f32 v126, v126
    v_rcp_f32 v127, v127
    s_nop 0
    v_pk_fma_f32 v[16:17], v[112:113], v[120:121], v[16:17]
    v_pk_fma_f32 v[18:19], v[114:115], v[122:123], v[18:19]
    v_pk_fma_f32 v[20:21], v[116:117], v[124:125], v[20:21]
    v_pk_fma_f32 v[22:23], v[118:119], v[126:127], v[22:23]
    v_pk_fma_f32 v[112:113], v[54:55], v[8:9], v[88:89] op_sel:[1,0,0] op_sel_hi:[1,1,1]
    v_pk_fma_f32 v[114:115], v[54:55], v[10:11], v[90:91] op_sel:[1,0,0] op_sel_hi:[1,1,1]
    v_pk_fma_f32 v[116:117], v[54:55], v[12:13], v[92:93] op_sel:[1,0,0] op_sel_hi:[1,1,1]
    v_pk_fma_f32 v[118:119], v[54:55], v[14:15], v[94:95] op_sel:[1,0,0] op_sel_hi:[1,1,1]
    v_add_u32 v7, v6, v3
    v_lshrrev_b32 v5, 24, v40
    v_mad_u32_u24 v5, v5, s50, v2
    ds_read_b128 v[88:91], v5
    ds_read_b128 v[92:95], v5 offset:128
    ds_read_b128 v[48:51], v4 offset:96
    ds_read_b128 v[52:55], v4 offset:112
    v_add_u32 v4, 64, v4
    v_dot2_f32_bf16 v116, v84, s78, v116
    v_dot2_f32_bf16 v117, v85, s78, v117
    v_dot2_f32_bf16 v118, v86, s78, v118
    v_dot2_f32_bf16 v119, v87, s78, v119
    v_pk_add_f32 v[112:113], v[84:85], v[112:113]
    v_pk_add_f32 v[114:115], v[86:87], v[114:115]
    v_exp_f32 v120, v112
    v_exp_f32 v121, v113
    v_exp_f32 v122, v114
    v_exp_f32 v123, v115
    v_exp_f32 v124, v116
    v_exp_f32 v125, v117
    v_exp_f32 v126, v118
    v_exp_f32 v127, v119
    v_pk_add_f32 v[120:121], v[120:121], 1.0 op_sel_hi:[1,0]
    v_pk_add_f32 v[122:123], v[122:123], 1.0 op_sel_hi:[1,0]
    v_pk_add_f32 v[124:125], v[124:125], 1.0 op_sel_hi:[1,0]
    v_pk_add_f32 v[126:127], v[126:127], 1.0 op_sel_hi:[1,0]
    v_rcp_f32 v120, v120
    v_rcp_f32 v121, v121
    v_rcp_f32 v122, v122
    v_rcp_f32 v123, v123
    v_rcp_f32 v124, v124
    v_rcp_f32 v125, v125
    v_rcp_f32 v126, v126
    v_rcp_f32 v127, v127
    s_nop 0
    v_pk_fma_f32 v[16:17], v[112:113], v[120:121], v[16:17]
    v_pk_fma_f32 v[18:19], v[114:115], v[122:123], v[18:19]
    v_pk_fma_f32 v[20:21], v[116:117], v[124:125], v[20:21]
    v_pk_fma_f32 v[22:23], v[118:119], v[126:127], v[22:23]
    ds_write_b128 v7, v[16:19]
    ds_write_b128 v7, v[20:23] offset:128
    s_cmp_eq_u32 s77, 0
    s_cbranch_scc1 K2_MAIN_DONE
    s_sub_u32 s77, s77, 1
    v_cmp_ne_u32 vcc, v6, v5
    s_and_saveexec_b64 s[80:81], vcc
    s_cbranch_execz K2_KEEP_SB
    v_mov_b64 v[16:17], 0
    v_mov_b64 v[18:19], 0
    v_mov_b64 v[20:21], 0
    v_mov_b64 v[22:23], 0
K2_KEEP_SB:
    s_mov_b64 exec, -1
    s_branch K2_LOOP_SA
K2_MAIN_DONE:
    s_waitcnt lgkmcnt(0)
    s_cmp_ge_u32 s22, 14
    s_cbranch_scc1 K2_IDLE
    v_and_b32 v6, 15, v0
    s_lshl_b32 s3, s86, 4
    v_add_u32 v6, s3, v6
    v_and_b32 v5, 48, v0
    v_lshlrev_b32 v7, 2, v6
    s_lshl_b32 s3, s87, 6
    v_add_u32 v36, s3, v5
    v_mad_u32_u24 v37, v6, s50, v36
    v_add_u32 v37, 38656, v37
    s_movk_i32 s3, 144
    v_mad_u32_u24 v41, v6, s3, v36
    v_mad_u32_u24 v42, v6, s3, v5
    v_lshlrev_b32 v40, 4, v0
    v_and_b32 v40, 0x70, v40
    v_xor_b32 v40, v40, v5
    v_lshl_add_u32 v40, v6, 7, v40
    v_add_u32 v40, 130688, v40
    v_xor_b32 v44, 64, v40
    v_and_b32 v43, 63, v0
    v_lshlrev_b32 v43, 4, v43
    s_lshl_b32 s3, s87, 13
    s_add_u32 s3, s3, 145024
    v_add_u32 v43, s3, v43
    ds_read_b128 v[88:91], v40
    ds_read_b128 v[92:95], v44
    ds_read_b128 v[56:59], v43 offset:0
    ds_read_b128 v[72:75], v43 offset:4096
    ds_read_b128 v[60:63], v43 offset:1024
    ds_read_b128 v[76:79], v43 offset:5120
    ds_read_b128 v[64:67], v43 offset:2048
    ds_read_b128 v[80:83], v43 offset:6144
    ds_read_b128 v[68:71], v43 offset:3072
    ds_read_b128 v[84:87], v43 offset:7168
    s_mov_b64 s[44:45], s[16:17]
    s_mov_b32 s46, 3200000
    s_mov_b32 s47, 0x20000
    s_mov_b32 s90, 0xbf317218
    s_mov_b32 s91, s90
    s_waitcnt lgkmcnt(0)
    v_mfma_f32_16x16x32_bf16 v[48:51], v[56:59], v[88:91], 0
    v_mfma_f32_16x16x32_bf16 v[52:55], v[72:75], v[88:91], 0
    v_mfma_f32_16x16x32_bf16 v[48:51], v[60:63], v[92:95], v[48:51]
    v_mfma_f32_16x16x32_bf16 v[52:55], v[76:79], v[92:95], v[52:55]
    s_barrier
    ds_read_b32 v38, v7 offset:1280
    s_cmp_eq_u32 s49, 0
    s_cbranch_scc1 K2_R0
    v_add_u32 v39, 61472, v37
    ds_read_b128 v[104:107], v39
    ds_read_b128 v[108:111], v39 offset:128
    s_waitcnt lgkmcnt(0)
    v_exp_f32 v96, v104
    v_exp_f32 v97, v105
    v_exp_f32 v98, v106
    v_exp_f32 v99, v107
    v_exp_f32 v100, v108
    v_exp_f32 v101, v109
    v_exp_f32 v102, v110
    v_exp_f32 v103, v111
    s_nop 0
    v_pk_add_f32 v[96:97], v[96:97], 1.0 op_sel_hi:[1,0]
    v_pk_add_f32 v[98:99], v[98:99], 1.0 op_sel_hi:[1,0]
    v_pk_add_f32 v[100:101], v[100:101], 1.0 op_sel_hi:[1,0]
    v_pk_add_f32 v[102:103], v[102:103], 1.0 op_sel_hi:[1,0]
    v_rcp_f32 v96, v96
    v_rcp_f32 v97, v97
    v_rcp_f32 v98, v98
    v_rcp_f32 v99, v99
    v_rcp_f32 v100, v100
    v_rcp_f32 v101, v101
    v_rcp_f32 v102, v102
    v_rcp_f32 v103, v103
    s_nop 0
    v_pk_mul_f32 v[96:97], v[96:97], v[104:105]
    v_pk_mul_f32 v[98:99], v[98:99], v[106:107]
    v_pk_mul_f32 v[100:101], v[100:101], v[108:109]
    v_pk_mul_f32 v[102:103], v[102:103], v[110:111]
    v_lshrrev_b32 v39, 16, v38
    v_cvt_f32_u32 v39, v39
    v_cmp_lt_f32 vcc, 0, v39
    s_and_saveexec_b64 s[80:81], vcc
    v_fma_f32 v24, -v39, v96, v24
    v_fma_f32 v25, -v39, v97, v25
    v_fma_f32 v26, -v39, v98, v26
    v_fma_f32 v27, -v39, v99, v27
    v_fma_f32 v28, -v39, v100, v28
    v_fma_f32 v29, -v39, v101, v29
    v_fma_f32 v30, -v39, v102, v30
    v_fma_f32 v31, -v39, v103, v31
    s_mov_b64 exec, -1
    v_and_b32 v39, 0xff, v38
    v_mad_u32_u24 v37, v39, s50, v37
    v_bfe_u32 v38, v38, 8, 8
    s_branch K2_RED
K2_R0:
    s_waitcnt lgkmcnt(0)
    v_and_b32 v39, 0xff, v38
    v_mad_u32_u24 v37, v39, s50, v37
    ds_read_b128 v[96:99], v37 offset:0
    ds_read_b128 v[100:103], v37 offset:128
    ds_read_b128 v[104:107], v37 offset:272
    ds_read_b128 v[108:111], v37 offset:400
    ds_read_b128 v[112:115], v37 offset:544
    ds_read_b128 v[116:119], v37 offset:672
    v_cvt_f32_ubyte2 v44, v38
    v_bfe_u32 v38, v38, 8, 8
    v_pk_mul_f32 v[24:25], v[24:25], v[44:45] op_sel_hi:[1,0] neg_lo:[0,1] neg_hi:[0,1]
    v_pk_mul_f32 v[26:27], v[26:27], v[44:45] op_sel_hi:[1,0] neg_lo:[0,1] neg_hi:[0,1]
    v_pk_mul_f32 v[28:29], v[28:29], v[44:45] op_sel_hi:[1,0] neg_lo:[0,1] neg_hi:[0,1]
    v_pk_mul_f32 v[30:31], v[30:31], v[44:45] op_sel_hi:[1,0] neg_lo:[0,1] neg_hi:[0,1]
    s_cmp_eq_u32 s84, 0
    s_cbranch_scc1 K2_RED2
    v_cmp_eq_f32 vcc, 0, v44
    s_and_b64 exec, exec, vcc
    v_mov_b64 v[24:25], 0
    v_mov_b64 v[26:27], 0
    v_mov_b64 v[28:29], 0
    v_mov_b64 v[30:31], 0
    s_mov_b64 exec, -1
    s_branch K2_RED2
K2_RED:
    ds_read_b128 v[96:99], v37 offset:0
    ds_read_b128 v[100:103], v37 offset:128
    ds_read_b128 v[104:107], v37 offset:272
    ds_read_b128 v[108:111], v37 offset:400
    ds_read_b128 v[112:115], v37 offset:544
    ds_read_b128 v[116:119], v37 offset:672
K2_RED2:
    v_add_u32 v37, 816, v37
    v_cmp_lt_i32 vcc, 0, v38
    s_and_b64 exec, exec, vcc
    s_waitcnt lgkmcnt(4)
    v_pk_add_f32 v[24:25], v[24:25], v[96:97]
    v_pk_add_f32 v[26:27], v[26:27], v[98:99]
    v_pk_add_f32 v[28:29], v[28:29], v[100:101]
    v_pk_add_f32 v[30:31], v[30:31], v[102:103]
    v_cmp_lt_i32 vcc, 1, v38
    s_and_b64 exec, exec, vcc
    s_waitcnt lgkmcnt(2)
    v_pk_add_f32 v[24:25], v[24:25], v[104:105]
    v_pk_add_f32 v[26:27], v[26:27], v[106:107]
    v_pk_add_f32 v[28:29], v[28:29], v[108:109]
    v_pk_add_f32 v[30:31], v[30:31], v[110:111]
    v_cmp_lt_i32 vcc, 2, v38
    s_and_b64 exec, exec, vcc
    s_waitcnt lgkmcnt(0)
    v_pk_add_f32 v[24:25], v[24:25], v[112:113]
    v_pk_add_f32 v[26:27], v[26:27], v[114:115]
    v_pk_add_f32 v[28:29], v[28:29], v[116:117]
    v_pk_add_f32 v[30:31], v[30:31], v[118:119]
    v_cmp_lt_i32 vcc, 3, v38
    v_subrev_u32 v38, 3, v38
    s_and_b64 exec, exec, vcc
    s_cbranch_execnz K2_RED
    s_mov_b64 exec, -1
    s_cmp_eq_u32 s85, 0
    s_cbranch_scc1 K2_FINAL
K2_NEXT:
    s_add_u32 s23, s23, s48
    s_add_u32 s49, s49, 1
K2_REDO:
    s_waitcnt lgkmcnt(0)
    s_barrier
    v_mov_b32 v120, 0x62ffff80
    v_mov_b32 v121, 0
    v_mov_b32 v122, v120
    v_mov_b32 v123, 0
    v_lshlrev_b32 v124, 4, v0
    ds_write_b128 v124, v[120:123] offset:1792
    ds_write_b128 v124, v[120:123] offset:18176
    s_cmp_gt_u32 s22, 3
    s_cbranch_scc1 K2_PF1_1
    ds_write_b128 v124, v[120:123] offset:34560
K2_PF1_1:
    s_cmp_lg_u32 s22, 15
    s_cbranch_scc1 K2_PF2_1
    v_and_b32 v125, 63, v0
    v_lshlrev_b32 v125, 3, v125
    v_mov_b32 v120, 0
    ds_write_b64 v125, v[120:121] offset:0
    ds_write_b32 v121, v120 offset:1156
K2_PF2_1:
    v_and_b32 v7, 15, v0
    v_add_u32 v7, s23, v7
    v_add_u32 v6, 16, v7
    s_cmp_eq_u32 s48, 32
    s_cbranch_scc1 K2_WIDE
    v_mov_b32 v6, 0x100000
K2_WIDE:
    s_waitcnt lgkmcnt(0)
    s_barrier
    s_branch K2_ROUND
K2_NARROW:
    s_mov_b32 s48, 16
    s_branch K2_REDO
K2_IDLE:
    s_barrier
    s_cmp_eq_u32 s85, 0
    s_cbranch_scc0 K2_NEXT
    s_branch K2_END
K2_FINAL:
    v_pk_mul_f32 v[24:25], v[24:25], s[90:91]
    v_pk_mul_f32 v[26:27], v[26:27], s[90:91]
    v_pk_mul_f32 v[28:29], v[28:29], s[90:91]
    v_pk_mul_f32 v[30:31], v[30:31], s[90:91]
    v_cvt_pk_bf16_f32 v96, v28, v24
    v_cvt_pk_bf16_f32 v97, v29, v25
    v_cvt_pk_bf16_f32 v98, v30, v26
    v_cvt_pk_bf16_f32 v99, v31, v27
    ds_write_b128 v41, v[96:99] offset:1792
    s_mul_i32 s3, s22, 1280
    v_and_b32 v36, 15, v0
    v_mul_u32_u24 v36, 80, v36
    v_add3_u32 v36, v36, v5, s3
    v_bfe_u32 v37, v0, 2, 4
    v_and_b32 v38, 3, v0
    v_lshlrev_b32 v38, 4, v38
    v_mul_u32_u24 v39, 80, v37
    v_add3_u32 v39, v39, v38, s3
    v_lshl_add_u32 v4, v37, 7, v38
    s_lshl_b32 s3, s87, 6
    s_add_u32 s3, s3, s88
    v_add_u32 v4, s3, v4
    s_lshl_b32 s3, s86, 4
    s_sub_u32 s3, 98, s3
    v_cmp_gt_u32 vcc, s3, v37
    s_mov_b32 s90, 0xbfb8aa3b
    s_mov_b32 s91, s90
    s_waitcnt lgkmcnt(0)
    s_barrier
    ds_read_b128 v[96:99], v42 offset:1792
    ds_read_b128 v[100:103], v42 offset:1856
    s_waitcnt lgkmcnt(1)
    v_mfma_f32_16x16x32_bf16 v[48:51], v[64:67], v[96:99], v[48:51]
    v_mfma_f32_16x16x32_bf16 v[52:55], v[80:83], v[96:99], v[52:55]
    s_waitcnt lgkmcnt(0)
    v_mfma_f32_16x16x32_bf16 v[48:51], v[68:71], v[100:103], v[48:51]
    v_mfma_f32_16x16x32_bf16 v[52:55], v[84:87], v[100:103], v[52:55]
    s_nop 7
    v_pk_mul_f32 v[112:113], v[48:49], s[90:91]
    v_pk_mul_f32 v[114:115], v[50:51], s[90:91]
    v_pk_mul_f32 v[116:117], v[52:53], s[90:91]
    v_pk_mul_f32 v[118:119], v[54:55], s[90:91]
    v_exp_f32 v112, v112
    v_exp_f32 v113, v113
    v_exp_f32 v114, v114
    v_exp_f32 v115, v115
    v_exp_f32 v116, v116
    v_exp_f32 v117, v117
    v_exp_f32 v118, v118
    v_exp_f32 v119, v119
    s_nop 0
    v_pk_add_f32 v[112:113], v[112:113], 1.0 op_sel_hi:[1,0]
    v_pk_add_f32 v[114:115], v[114:115], 1.0 op_sel_hi:[1,0]
    v_pk_add_f32 v[116:117], v[116:117], 1.0 op_sel_hi:[1,0]
    v_pk_add_f32 v[118:119], v[118:119], 1.0 op_sel_hi:[1,0]
    v_rcp_f32 v112, v112
    v_rcp_f32 v113, v113
    v_rcp_f32 v114, v114
    v_rcp_f32 v115, v115
    v_rcp_f32 v116, v116
    v_rcp_f32 v117, v117
    v_rcp_f32 v118, v118
    v_rcp_f32 v119, v119
    s_nop 0
    v_pk_mul_f32 v[112:113], v[112:113], v[48:49]
    v_pk_mul_f32 v[114:115], v[114:115], v[50:51]
    v_pk_mul_f32 v[116:117], v[116:117], v[52:53]
    v_pk_mul_f32 v[118:119], v[118:119], v[54:55]
    v_cvt_pk_bf16_f32 v120, v112, v113
    v_cvt_pk_bf16_f32 v121, v114, v115
    v_cvt_pk_bf16_f32 v122, v116, v117
    v_cvt_pk_bf16_f32 v123, v118, v119
    ds_write_b128 v36, v[120:123] offset:18176
    s_waitcnt lgkmcnt(0)
    ds_read_b128 v[120:123], v39 offset:18176
    s_and_b64 exec, exec, vcc
    s_cbranch_execz K2_END
    s_waitcnt lgkmcnt(0)
    buffer_store_dwordx4 v[120:123], v4, s[44:47], 0 offen sc1
K2_END:
K2_EXIT:
    s_endpgm
.section .rodata,"a"
.p2align 6
.amdhsa_kernel gather_scatter__mpnn_edge_mlp__graph_kernel
  .amdhsa_next_free_vgpr 128
  .amdhsa_next_free_sgpr 100
  .amdhsa_accum_offset 128
  .amdhsa_group_segment_fixed_size 0
  .amdhsa_kernarg_size 72
  .amdhsa_user_sgpr_count 2
  .amdhsa_user_sgpr_kernarg_segment_ptr 1
  .amdhsa_system_sgpr_workgroup_id_x 1
  .amdhsa_float_denorm_mode_32 3
.end_amdhsa_kernel
```
